```python
import torch

def _softmax(x, axis=-1):
    return torch.softmax(x, dim=axis)
def _gelu(x):
    return torch.nn.functional.gelu(x, approximate="tanh")
def _silu(x):
    return torch.nn.functional.silu(x)
def _sigmoid(x):
    return torch.sigmoid(x)
def _layernorm(x, axis=-1, eps=1e-5):
    m = x.mean(dim=axis, keepdim=True)
    v = x.var(dim=axis, keepdim=True, unbiased=False)
    return (x - m) / torch.sqrt(v + eps)
def _scatter_add(tgt, idx, src, axis=0):
    return tgt.clone().index_add_(axis, idx, src)
def _segment_sum(src, seg, n):
    out = torch.zeros((n,) + src.shape[1:], dtype=src.dtype)
    return out.index_add_(0, seg, src)
def _pad(x, pw):
    flat = tuple(v for pair in reversed(pw) for v in pair)
    return torch.nn.functional.pad(x, flat)

kernel_name = 'concat_heads__ssm_conv_s5__mha_block__prompt'

def setup_inputs():

    _w = (lambda a: (lambda t: t.to(torch.bfloat16) if t.is_floating_point() else t)(torch.as_tensor(a)))
    def _A_setup():
        B, S, D = 1, 2048, 576
        P = D
        Lambda_re = -0.5 * (lambda _x: torch.exp(torch.as_tensor(_x)))((lambda *s: torch.randn(*s, dtype=torch.bfloat16) * 0.4)(P))
        Lambda_im = (lambda *s: torch.randn(*s, dtype=torch.bfloat16) * 0.8)(P) * 1.0
        B_re = (lambda *s: torch.randn(*s, dtype=torch.bfloat16) * 0.8)(P, D) * (D ** -0.5)
        B_im = (lambda *s: torch.randn(*s, dtype=torch.bfloat16) * 0.8)(P, D) * (D ** -0.5)
        C_re = (lambda *s: torch.randn(*s, dtype=torch.bfloat16) * 0.8)(D, P) * (P ** -0.5)
        C_im = (lambda *s: torch.randn(*s, dtype=torch.bfloat16) * 0.8)(D, P) * (P ** -0.5)
        log_dt = (lambda *s: torch.randn(*s, dtype=torch.bfloat16) * 0.4)(P) * 0.3 - 2.0
        Dskip = (lambda *s: torch.randn(*s, dtype=torch.bfloat16) * 0.1)(D)
        return {
            "x": _w((lambda *s: torch.randn(*s, dtype=torch.bfloat16) * 0.05)(B, S, D)),
            "Lambda_re": _w(Lambda_re),
            "Lambda_im": _w(Lambda_im),
            "B_re": _w(B_re),
            "B_im": _w(B_im),
            "C_re": _w(C_re),
            "C_im": _w(C_im),
            "log_dt": _w(log_dt),
            "Dskip": _w(Dskip),
        }
    _A_in = _A_setup()

    def _B_setup():
        B, S, D, H = 1, 2048, 576, 32
        return {
            "x": _w((lambda *s: torch.randn(*s, dtype=torch.bfloat16) * 0.2)(B, S, D)),
            "wqkv": _w((lambda *s: torch.randn(*s, dtype=torch.bfloat16) * 0.2)(D, 3 * D)),
            "wo": _w((lambda *s: torch.randn(*s, dtype=torch.bfloat16) * 0.05)(D, D)),
        }
    _B_in = _B_setup()

    return {
        "A_x": _A_in["x"],
        "A_Lambda_re": _A_in["Lambda_re"],
        "A_Lambda_im": _A_in["Lambda_im"],
        "A_B_re": _A_in["B_re"],
        "A_B_im": _A_in["B_im"],
        "A_C_re": _A_in["C_re"],
        "A_C_im": _A_in["C_im"],
        "A_log_dt": _A_in["log_dt"],
        "A_Dskip": _A_in["Dskip"],
        "B_x": _B_in["x"],
        "B_wqkv": _B_in["wqkv"],
        "B_wo": _B_in["wo"],
    }

def reference(A_x, A_Lambda_re, A_Lambda_im, A_B_re, A_B_im, A_C_re, A_C_im, A_log_dt, A_Dskip, B_x, B_wqkv, B_wo):
    def _A_ref(x, Lambda_re, Lambda_im, B_re, B_im, C_re, C_im, log_dt, Dskip):
        Bsz, L, H = x.shape
        Lam = Lambda_re + 1j * Lambda_im
        Bmat = B_re + 1j * B_im
        Cmat = C_re + 1j * C_im
        dt = torch.exp(log_dt)
        Lam_bar = torch.exp(dt * Lam)
        B_bar = ((Lam_bar - 1.0) / Lam)[:, None] * Bmat
        Bu = torch.einsum("bld,pd->blp", x + 0j, B_bar)
        h = torch.zeros_like(Bu[:, 0, :])
        hs = []
        for t in range(L):
            h = Lam_bar[None, :] * h + Bu[:, t, :]
            hs.append(h)
        hseq = torch.stack(hs, 1)
        y = 2.0 * torch.einsum("blp,dp->bld", hseq, Cmat).real + x * Dskip[None, None, :]
        return y

    def _B_ref(x, wqkv, wo):
        B, S, D = x.shape
        H = 32
        Dh = D // H
        qkv = (lambda x, *d: x.permute(*d))((x @ wqkv).reshape(B, S, 3, H, Dh), 2, 0, 3, 1, 4)
        q, k, v = qkv[0], qkv[1], qkv[2]
        scores = torch.einsum("bhqd,bhkd->bhqk", q, k) * (Dh ** -0.5)
        p = _softmax(scores, axis=-1)
        o = torch.einsum("bhqk,bhkd->bhqd", p, v)
        return (lambda x, *d: x.permute(*d))(o, 0, 2, 1, 3).reshape(B, S, D) @ wo

    a = _A_ref(A_x, A_Lambda_re, A_Lambda_im, A_B_re, A_B_im, A_C_re, A_C_im, A_log_dt, A_Dskip)
    b = _B_ref(B_x, B_wqkv, B_wo)
    return torch.concatenate([a, b], axis=-1)
```

```asm
; @launch kernel=k1_kernel grid=(256,1,1) block=(512,1,1) lds=139264
; @launch kernel=k2_kernel grid=(512,1,1) block=(512,1,1) lds=81920
.amdgcn_target "amdgcn-amd-amdhsa--gfx950"
.text
.globl k1_kernel
.p2align 8
.type k1_kernel,@function
k1_kernel:
  s_cmp_ge_u32 s2, 256
  s_cbranch_scc1 L_k1_exit
  s_cmp_ge_u32 s2, 192
  s_cbranch_scc1 L_k1_prep
  s_load_dwordx2 s[4:5], s[0:1], 72
  s_load_dwordx2 s[6:7], s[0:1], 80
  s_load_dwordx2 s[34:35], s[0:1], 112
  v_and_b32 v1, 63, v0
  v_lshrrev_b32 v2, 6, v0
  s_and_b32 s36, s2, 7
  v_readfirstlane_b32 s20, v2
  s_lshr_b32 s37, s2, 3
  s_lshr_b32 s21, s36, 1
  s_lshl_b32 s21, s21, 2
  s_and_b32 s38, s37, 3
  s_add_u32 s21, s21, s38
  s_and_b32 s22, s36, 1
  s_mul_i32 s22, s22, 6
  s_lshr_b32 s38, s37, 2
  s_add_u32 s22, s22, s38
  s_lshr_b32 s23, s22, 2
  s_waitcnt lgkmcnt(0)
  s_mov_b32 s8, s4
  s_and_b32 s9, s5, 0xffff
  s_mov_b32 s10, 2359296
  s_mov_b32 s11, 0x20000
  s_mov_b32 s12, s6
  s_and_b32 s13, s7, 0xffff
  s_mov_b32 s14, 1990656
  s_mov_b32 s15, 0x20000
  s_lshl_b32 s47, s2, 9
  v_add_u32 v2, s47, v0
  v_lshlrev_b32 v5, 7, v2
  s_cmp_lt_u32 s2, 31
  s_cbranch_scc0 L_k1_lw1_3
  buffer_load_dword v230, v5, s[12:15], 0 offen
  s_branch L_k1_lw2_4
L_k1_lw1_3:
  s_cmp_lt_u32 s2, 67
  s_cbranch_scc0 L_k1_lw3_5
  v_subrev_u32 v5, 2031616, v5
  buffer_load_dword v231, v5, s[8:11], 0 offen
  s_branch L_k1_lw2_4
L_k1_lw3_5:
  s_cmp_lt_u32 s2, 125
  s_cbranch_scc0 L_k1_lw2_4
  s_cmp_lt_u32 s2, 103
  s_cselect_b32 s48, 0, 24
  s_mov_b32 s49, 103
  s_cselect_b32 s49, 67, s49
  s_cbranch_scc1 L_k1_lw4_6
  s_cmp_lt_u32 s2, 114
  s_cselect_b32 s48, 24, 32
  s_mov_b32 s49, 114
  s_cselect_b32 s49, 103, s49
L_k1_lw4_6:
  s_cmp_eq_u32 s48, 0
  s_cbranch_scc1 L_k1_lw4_6_x
  s_cmp_eq_u32 s48, 24
  s_cbranch_scc1 L_k1_lw4_6_r
  s_load_dwordx2 s[52:53], s[0:1], 32
  s_branch L_k1_lw4_6_l
L_k1_lw4_6_r:
  s_load_dwordx2 s[52:53], s[0:1], 24
  s_branch L_k1_lw4_6_l
L_k1_lw4_6_x:
  s_load_dwordx2 s[52:53], s[0:1], 0
L_k1_lw4_6_l:
  s_cmp_eq_u32 s48, 0
  s_mov_b32 s54, 663552
  s_cselect_b32 s54, 2359296, s54
  s_mov_b32 s55, 0x20000
  s_lshl_b32 s49, s49, 16
  v_subrev_u32 v5, s49, v5
  s_waitcnt lgkmcnt(0)
  s_and_b32 s53, s53, 0xffff
  buffer_load_dword v231, v5, s[52:55], 0 offen
L_k1_lw2_4:
  s_cmp_ge_u32 s20, 4
  s_cbranch_scc1 L_k1_loader_1
  v_and_b32 v2, 15, v1
  v_lshrrev_b32 v216, 4, v1
  v_lshrrev_b32 v4, 1, v2
  v_xor_b32 v4, v4, v216
  s_lshl_b32 s38, s20, 5
  v_add_u32 v5, s38, v2
  v_lshlrev_b32 v5, 7, v5
  v_lshlrev_b32 v6, 4, v4
  v_add_u32 v6, v6, v5
  v_xor_b32 v7, 64, v6
  v_lshrrev_b32 v4, 2, v2
  v_lshlrev_b32 v5, 3, v216
  v_add_u32 v4, v4, v5
  v_mul_u32_u24 v4, 288, v4
  v_and_b32 v5, 3, v1
  v_lshlrev_b32 v5, 3, v5
  v_add_u32 v4, v4, v5
  v_add_u32 v4, 16384, v4
  v_and_b32 v5, 1, v216
  v_lshlrev_b32 v3, 7, v5
  v_add_u32 v10, v4, v3
  v_mul_u32_u24 v3, 160, v5
  v_sub_u32 v11, v4, v3
  v_mov_b32 v8, v6
  v_mov_b32 v9, v7
  v_mov_b32 v12, v10
  v_mov_b32 v13, v11
  v_mov_b32 v104, 0
  v_mov_b32 v105, 0
  v_mov_b32 v106, 0
  v_mov_b32 v107, 0
  v_mov_b32 v108, 0
  v_mov_b32 v109, 0
  v_mov_b32 v110, 0
  v_mov_b32 v111, 0
  v_mov_b32 v112, 0
  v_mov_b32 v113, 0
  v_mov_b32 v114, 0
  v_mov_b32 v115, 0
  v_mov_b32 v116, 0
  v_mov_b32 v117, 0
  v_mov_b32 v118, 0
  v_mov_b32 v119, 0
  v_mov_b32 v120, 0
  v_mov_b32 v121, 0
  v_mov_b32 v122, 0
  v_mov_b32 v123, 0
  v_mov_b32 v124, 0
  v_mov_b32 v125, 0
  v_mov_b32 v126, 0
  v_mov_b32 v127, 0
  v_mov_b32 v128, 0
  v_mov_b32 v129, 0
  v_mov_b32 v130, 0
  v_mov_b32 v131, 0
  v_mov_b32 v132, 0
  v_mov_b32 v133, 0
  v_mov_b32 v134, 0
  v_mov_b32 v135, 0
  v_mov_b32 v136, 0
  v_mov_b32 v137, 0
  v_mov_b32 v138, 0
  v_mov_b32 v139, 0
  v_mov_b32 v140, 0
  v_mov_b32 v141, 0
  v_mov_b32 v142, 0
  v_mov_b32 v143, 0
  v_mov_b32 v144, 0
  v_mov_b32 v145, 0
  v_mov_b32 v146, 0
  v_mov_b32 v147, 0
  v_mov_b32 v148, 0
  v_mov_b32 v149, 0
  v_mov_b32 v150, 0
  v_mov_b32 v151, 0
  v_mov_b32 v152, 0
  v_mov_b32 v153, 0
  v_mov_b32 v154, 0
  v_mov_b32 v155, 0
  v_mov_b32 v156, 0
  v_mov_b32 v157, 0
  v_mov_b32 v158, 0
  v_mov_b32 v159, 0
  v_mov_b32 v160, 0
  v_mov_b32 v161, 0
  v_mov_b32 v162, 0
  v_mov_b32 v163, 0
  v_mov_b32 v164, 0
  v_mov_b32 v165, 0
  v_mov_b32 v166, 0
  v_mov_b32 v167, 0
  v_mov_b32 v168, 0
  v_mov_b32 v169, 0
  v_mov_b32 v170, 0
  v_mov_b32 v171, 0
  v_mov_b32 v172, 0
  v_mov_b32 v173, 0
  v_mov_b32 v174, 0
  v_mov_b32 v175, 0
  v_lshlrev_b32 v212, 4, v2
  v_lshlrev_b32 v213, 2, v2
  v_lshlrev_b32 v3, 4, v216
  s_cmp_eq_u32 s23, 2
  s_cbranch_scc1 L_k1_ev_7
  s_mul_i32 s39, s20, 1152
  v_add_u32 v212, s39, v212
  v_add_u32 v213, s39, v213
  s_mov_b32 s40, 0x80000
  s_mov_b32 s41, 0x2080200
  v_lshrrev_b64 v[214:215], v3, s[40:41]
  v_and_b32 v214, 0xffff, v214
  v_add_u32 v176, v214, v212
  v_add_u32 v194, 256, v176
  s_mov_b32 s40, 0xc0004
  s_mov_b32 s41, 0x20c0204
  v_lshrrev_b64 v[214:215], v3, s[40:41]
  v_and_b32 v214, 0xffff, v214
  v_add_u32 v177, v214, v212
  v_add_u32 v195, 256, v177
  s_mov_b32 s40, 0x12040400
  s_mov_b32 s41, 0x1404120c
  v_lshrrev_b64 v[214:215], v3, s[40:41]
  v_and_b32 v214, 0xffff, v214
  v_cmp_eq_u32 vcc, 0, v216
  v_add_u32 v178, v214, v212
  v_add_u32 v214, v214, v213
  v_cndmask_b32 v178, v178, v214, vcc
  v_mov_b32 v214, 256
  v_mov_b32 v215, 64
  v_cndmask_b32 v214, v214, v215, vcc
  v_add_u32 v196, v178, v214
  s_mov_b32 s40, 0x12081200
  s_mov_b32 s41, 0x14081400
  v_lshrrev_b64 v[214:215], v3, s[40:41]
  v_and_b32 v214, 0xffff, v214
  v_add_u32 v179, v214, v212
  v_add_u32 v197, 256, v179
  s_mov_b32 s40, 0x2400140c
  s_mov_b32 s41, 0x26002408
  v_lshrrev_b64 v[214:215], v3, s[40:41]
  v_and_b32 v214, 0xffff, v214
  v_add_u32 v180, v214, v212
  v_add_u32 v198, 256, v180
  s_mov_b32 s40, 0x24041600
  s_mov_b32 s41, 0x2604240c
  v_lshrrev_b64 v[214:215], v3, s[40:41]
  v_and_b32 v214, 0xffff, v214
  v_cmp_eq_u32 vcc, 0, v216
  v_add_u32 v181, v214, v212
  v_add_u32 v214, v214, v213
  v_cndmask_b32 v181, v181, v214, vcc
  v_mov_b32 v214, 256
  v_mov_b32 v215, 64
  v_cndmask_b32 v214, v214, v215, vcc
  v_add_u32 v199, v181, v214
  s_mov_b32 s40, 0x28002608
  s_mov_b32 s41, 0x360c3604
  v_lshrrev_b64 v[214:215], v3, s[40:41]
  v_and_b32 v214, 0xffff, v214
  v_cmp_eq_u32 vcc, 1, v216
  v_add_u32 v182, v214, v212
  v_add_u32 v214, v214, v213
  v_cndmask_b32 v182, v182, v214, vcc
  v_mov_b32 v214, 256
  v_mov_b32 v215, 64
  v_cndmask_b32 v214, v214, v215, vcc
  v_add_u32 v200, v182, v214
  s_mov_b32 s40, 0x3600260c
  s_mov_b32 s41, 0x38003608
  v_lshrrev_b64 v[214:215], v3, s[40:41]
  v_and_b32 v214, 0xffff, v214
  v_add_u32 v183, v214, v212
  v_add_u32 v201, 256, v183
  s_mov_b32 s40, 0x380c3804
  s_mov_b32 s41, 0x48084800
  v_lshrrev_b64 v[214:215], v3, s[40:41]
  v_and_b32 v214, 0xffff, v214
  v_add_u32 v184, v214, v212
  v_add_u32 v202, 256, v184
  s_mov_b32 s40, 0x3a003808
  s_mov_b32 s41, 0x480c4804
  v_lshrrev_b64 v[214:215], v3, s[40:41]
  v_and_b32 v214, 0xffff, v214
  v_cmp_eq_u32 vcc, 1, v216
  v_add_u32 v185, v214, v212
  v_add_u32 v214, v214, v213
  v_cndmask_b32 v185, v185, v214, vcc
  v_mov_b32 v214, 256
  v_mov_b32 v215, 64
  v_cndmask_b32 v214, v214, v215, vcc
  v_add_u32 v203, v185, v214
  s_mov_b32 s40, 0x4a084a00
  s_mov_b32 s41, 0x5a044c00
  v_lshrrev_b64 v[214:215], v3, s[40:41]
  v_and_b32 v214, 0xffff, v214
  v_cmp_eq_u32 vcc, 2, v216
  v_add_u32 v186, v214, v212
  v_add_u32 v214, v214, v213
  v_cndmask_b32 v186, v186, v214, vcc
  v_mov_b32 v214, 256
  v_mov_b32 v215, 64
  v_cndmask_b32 v214, v214, v215, vcc
  v_add_u32 v204, v186, v214
  s_mov_b32 s40, 0x4a0c4a04
  s_mov_b32 s41, 0x5a085a00
  v_lshrrev_b64 v[214:215], v3, s[40:41]
  v_and_b32 v214, 0xffff, v214
  v_add_u32 v187, v214, v212
  v_add_u32 v205, 256, v187
  s_mov_b32 s40, 0x5c045a0c
  s_mov_b32 s41, 0x6c005c0c
  v_lshrrev_b64 v[214:215], v3, s[40:41]
  v_and_b32 v214, 0xffff, v214
  v_add_u32 v188, v214, v212
  v_add_u32 v206, 256, v188
  s_mov_b32 s40, 0x5c085c00
  s_mov_b32 s41, 0x6c045e00
  v_lshrrev_b64 v[214:215], v3, s[40:41]
  v_and_b32 v214, 0xffff, v214
  v_cmp_eq_u32 vcc, 2, v216
  v_add_u32 v189, v214, v212
  v_add_u32 v214, v214, v213
  v_cndmask_b32 v189, v189, v214, vcc
  v_mov_b32 v214, 256
  v_mov_b32 v215, 64
  v_cndmask_b32 v214, v214, v215, vcc
  v_add_u32 v207, v189, v214
  s_mov_b32 s40, 0x6e006c08
  s_mov_b32 s41, 0x70006e08
  v_lshrrev_b64 v[214:215], v3, s[40:41]
  v_and_b32 v214, 0xffff, v214
  v_cmp_eq_u32 vcc, 3, v216
  v_add_u32 v190, v214, v212
  v_add_u32 v214, v214, v213
  v_cndmask_b32 v190, v190, v214, vcc
  v_mov_b32 v214, 256
  v_mov_b32 v215, 64
  v_cndmask_b32 v214, v214, v215, vcc
  v_add_u32 v208, v190, v214
  s_mov_b32 s40, 0x6e046c0c
  s_mov_b32 s41, 0x7e006e0c
  v_lshrrev_b64 v[214:215], v3, s[40:41]
  v_and_b32 v214, 0xffff, v214
  v_add_u32 v191, v214, v212
  v_add_u32 v209, 256, v191
  s_mov_b32 s40, 0x7e0c7e04
  s_mov_b32 s41, 0x800c8004
  v_lshrrev_b64 v[214:215], v3, s[40:41]
  v_and_b32 v214, 0xffff, v214
  v_add_u32 v192, v214, v212
  v_add_u32 v210, 256, v192
  s_mov_b32 s40, 0x80007e08
  s_mov_b32 s41, 0x82008008
  v_lshrrev_b64 v[214:215], v3, s[40:41]
  v_and_b32 v214, 0xffff, v214
  v_cmp_eq_u32 vcc, 3, v216
  v_add_u32 v193, v214, v212
  v_add_u32 v214, v214, v213
  v_cndmask_b32 v193, v193, v214, vcc
  v_mov_b32 v214, 256
  v_mov_b32 v215, 64
  v_cndmask_b32 v214, v214, v215, vcc
  v_add_u32 v211, v193, v214
  s_branch L_k1_ed_8
L_k1_ev_7:
  v_and_b32 v4, 1, v216
  v_mul_u32_u24 v4, 320, v4
  v_lshrrev_b32 v3, 1, v216
  v_lshlrev_b32 v3, 3, v3
  v_add_u32 v3, v3, v4
  s_mul_i32 s39, s20, 1280
  v_add_u32 v3, s39, v3
  v_add_u32 v4, 0, v2
  v_mul_u32_u24 v5, 3641, v4
  v_lshrrev_b32 v5, 16, v5
  v_mul_u32_u24 v214, 18, v5
  v_sub_u32 v4, v4, v214
  v_mul_u32_u24 v5, 5120, v5
  v_lshlrev_b32 v4, 4, v4
  v_add3_u32 v176, v5, v4, v3
  v_add_u32 v4, 16, v2
  v_mul_u32_u24 v5, 3641, v4
  v_lshrrev_b32 v5, 16, v5
  v_mul_u32_u24 v214, 18, v5
  v_sub_u32 v4, v4, v214
  v_mul_u32_u24 v5, 5120, v5
  v_lshlrev_b32 v4, 4, v4
  v_add3_u32 v178, v5, v4, v3
  v_add_u32 v4, 32, v2
  v_mul_u32_u24 v5, 3641, v4
  v_lshrrev_b32 v5, 16, v5
  v_mul_u32_u24 v214, 18, v5
  v_sub_u32 v4, v4, v214
  v_mul_u32_u24 v5, 5120, v5
  v_lshlrev_b32 v4, 4, v4
  v_add3_u32 v180, v5, v4, v3
  v_add_u32 v4, 48, v2
  v_mul_u32_u24 v5, 3641, v4
  v_lshrrev_b32 v5, 16, v5
  v_mul_u32_u24 v214, 18, v5
  v_sub_u32 v4, v4, v214
  v_mul_u32_u24 v5, 5120, v5
  v_lshlrev_b32 v4, 4, v4
  v_add3_u32 v182, v5, v4, v3
  v_add_u32 v4, 64, v2
  v_mul_u32_u24 v5, 3641, v4
  v_lshrrev_b32 v5, 16, v5
  v_mul_u32_u24 v214, 18, v5
  v_sub_u32 v4, v4, v214
  v_mul_u32_u24 v5, 5120, v5
  v_lshlrev_b32 v4, 4, v4
  v_add3_u32 v184, v5, v4, v3
  v_add_u32 v4, 80, v2
  v_mul_u32_u24 v5, 3641, v4
  v_lshrrev_b32 v5, 16, v5
  v_mul_u32_u24 v214, 18, v5
  v_sub_u32 v4, v4, v214
  v_mul_u32_u24 v5, 5120, v5
  v_lshlrev_b32 v4, 4, v4
  v_add3_u32 v186, v5, v4, v3
  v_add_u32 v4, 96, v2
  v_mul_u32_u24 v5, 3641, v4
  v_lshrrev_b32 v5, 16, v5
  v_mul_u32_u24 v214, 18, v5
  v_sub_u32 v4, v4, v214
  v_mul_u32_u24 v5, 5120, v5
  v_lshlrev_b32 v4, 4, v4
  v_add3_u32 v188, v5, v4, v3
  v_add_u32 v4, 112, v2
  v_mul_u32_u24 v5, 3641, v4
  v_lshrrev_b32 v5, 16, v5
  v_mul_u32_u24 v214, 18, v5
  v_sub_u32 v4, v4, v214
  v_mul_u32_u24 v5, 5120, v5
  v_lshlrev_b32 v4, 4, v4
  v_add3_u32 v190, v5, v4, v3
  v_add_u32 v4, 128, v2
  v_mul_u32_u24 v5, 3641, v4
  v_lshrrev_b32 v5, 16, v5
  v_mul_u32_u24 v214, 18, v5
  v_sub_u32 v4, v4, v214
  v_mul_u32_u24 v5, 5120, v5
  v_lshlrev_b32 v4, 4, v4
  v_add3_u32 v192, v5, v4, v3
L_k1_ed_8:
  s_cmp_eq_u32 s23, 2
  s_cbranch_scc1 L_co_v_9
  s_cmp_eq_u32 s23, 0
  s_mov_b32 s38, 2432
  s_cselect_b32 s38, 1152, s38
  v_add_u32 v2, 0, v1
  v_mul_u32_u24 v3, 911, v2
  v_lshrrev_b32 v3, 16, v3
  v_mul_u32_u24 v4, 72, v3
  v_sub_u32 v4, v2, v4
  v_lshlrev_b32 v4, 4, v4
  v_mul_lo_u32 v3, v3, s38
  v_add_u32 v217, v3, v4
  v_add_u32 v2, 64, v1
  v_mul_u32_u24 v3, 911, v2
  v_lshrrev_b32 v3, 16, v3
  v_mul_u32_u24 v4, 72, v3
  v_sub_u32 v4, v2, v4
  v_lshlrev_b32 v4, 4, v4
  v_mul_lo_u32 v3, v3, s38
  v_add_u32 v218, v3, v4
  v_add_u32 v2, 128, v1
  v_mul_u32_u24 v3, 911, v2
  v_lshrrev_b32 v3, 16, v3
  v_mul_u32_u24 v4, 72, v3
  v_sub_u32 v4, v2, v4
  v_lshlrev_b32 v4, 4, v4
  v_mul_lo_u32 v3, v3, s38
  v_add_u32 v219, v3, v4
  v_add_u32 v2, 192, v1
  v_mul_u32_u24 v3, 911, v2
  v_lshrrev_b32 v3, 16, v3
  v_mul_u32_u24 v4, 72, v3
  v_sub_u32 v4, v2, v4
  v_lshlrev_b32 v4, 4, v4
  v_mul_lo_u32 v3, v3, s38
  v_add_u32 v220, v3, v4
  v_add_u32 v2, 256, v1
  v_mul_u32_u24 v3, 911, v2
  v_lshrrev_b32 v3, 16, v3
  v_mul_u32_u24 v4, 72, v3
  v_sub_u32 v4, v2, v4
  v_lshlrev_b32 v4, 4, v4
  v_mul_lo_u32 v3, v3, s38
  v_add_u32 v221, v3, v4
  s_branch L_co_e_10
L_co_v_9:
  v_add_u32 v2, 0, v1
  v_mul_u32_u24 v3, 820, v2
  v_lshrrev_b32 v3, 16, v3
  v_mul_u32_u24 v4, 80, v3
  v_sub_u32 v4, v2, v4
  v_lshlrev_b32 v4, 4, v4
  v_mul_u32_u24 v3, 2432, v3
  v_add_u32 v217, v3, v4
  v_add_u32 v217, 1152, v217
  v_add_u32 v2, 64, v1
  v_mul_u32_u24 v3, 820, v2
  v_lshrrev_b32 v3, 16, v3
  v_mul_u32_u24 v4, 80, v3
  v_sub_u32 v4, v2, v4
  v_lshlrev_b32 v4, 4, v4
  v_mul_u32_u24 v3, 2432, v3
  v_add_u32 v218, v3, v4
  v_add_u32 v218, 1152, v218
  v_add_u32 v2, 128, v1
  v_mul_u32_u24 v3, 820, v2
  v_lshrrev_b32 v3, 16, v3
  v_mul_u32_u24 v4, 80, v3
  v_sub_u32 v4, v2, v4
  v_lshlrev_b32 v4, 4, v4
  v_mul_u32_u24 v3, 2432, v3
  v_add_u32 v219, v3, v4
  v_add_u32 v219, 1152, v219
  v_add_u32 v2, 192, v1
  v_mul_u32_u24 v3, 820, v2
  v_lshrrev_b32 v3, 16, v3
  v_mul_u32_u24 v4, 80, v3
  v_sub_u32 v4, v2, v4
  v_lshlrev_b32 v4, 4, v4
  v_mul_u32_u24 v3, 2432, v3
  v_add_u32 v220, v3, v4
  v_add_u32 v220, 1152, v220
  v_add_u32 v2, 256, v1
  v_mul_u32_u24 v3, 820, v2
  v_lshrrev_b32 v3, 16, v3
  v_mul_u32_u24 v4, 80, v3
  v_sub_u32 v4, v2, v4
  v_lshlrev_b32 v4, 4, v4
  v_mul_u32_u24 v3, 2432, v3
  v_add_u32 v221, v3, v4
  v_add_u32 v221, 1152, v221
L_co_e_10:
  s_barrier
  s_mov_b32 s27, 0
  s_mov_b32 s29, 0
  s_cmp_eq_u32 s23, 2
  s_cbranch_scc1 L_k1_v_11
  ds_read_b128 v[16:19], v8 offset:0
  ds_read_b128 v[20:23], v8 offset:2048
  ds_read_b64_tr_b16 v[32:33], v12 offset:0
  ds_read_b64_tr_b16 v[34:35], v12 offset:1152
  ds_read_b64_tr_b16 v[36:37], v12 offset:32
  ds_read_b64_tr_b16 v[38:39], v12 offset:1184
  ds_read_b64_tr_b16 v[40:41], v12 offset:64
  ds_read_b64_tr_b16 v[42:43], v12 offset:1216
  ds_read_b64_tr_b16 v[44:45], v12 offset:96
  ds_read_b64_tr_b16 v[46:47], v12 offset:1248
  ds_read_b64_tr_b16 v[48:49], v12 offset:128
  ds_read_b64_tr_b16 v[50:51], v12 offset:1280
  ds_read_b64_tr_b16 v[52:53], v13 offset:160
  ds_read_b64_tr_b16 v[54:55], v13 offset:1312
  ds_read_b64_tr_b16 v[56:57], v13 offset:192
  ds_read_b64_tr_b16 v[58:59], v13 offset:1344
  ds_read_b64_tr_b16 v[60:61], v13 offset:224
  ds_read_b64_tr_b16 v[62:63], v13 offset:1376
  ds_read_b64_tr_b16 v[64:65], v13 offset:256
  ds_read_b64_tr_b16 v[66:67], v13 offset:1408
L_k1_loop_12:
  s_waitcnt lgkmcnt(0)
  v_mfma_f32_16x16x32_bf16 v[104:107], v[32:35], v[16:19], v[104:107]
  ds_read_b128 v[24:27], v9 offset:0
  ds_read_b128 v[28:31], v9 offset:2048
  v_mfma_f32_16x16x32_bf16 v[140:143], v[32:35], v[20:23], v[140:143]
  ds_read_b64_tr_b16 v[68:69], v12 offset:9216
  ds_read_b64_tr_b16 v[70:71], v12 offset:10368
  v_mfma_f32_16x16x32_bf16 v[108:111], v[36:39], v[16:19], v[108:111]
  ds_read_b64_tr_b16 v[72:73], v12 offset:9248
  v_mfma_f32_16x16x32_bf16 v[144:147], v[36:39], v[20:23], v[144:147]
  ds_read_b64_tr_b16 v[74:75], v12 offset:10400
  v_mfma_f32_16x16x32_bf16 v[112:115], v[40:43], v[16:19], v[112:115]
  ds_read_b64_tr_b16 v[76:77], v12 offset:9280
  v_mfma_f32_16x16x32_bf16 v[148:151], v[40:43], v[20:23], v[148:151]
  ds_read_b64_tr_b16 v[78:79], v12 offset:10432
  v_mfma_f32_16x16x32_bf16 v[116:119], v[44:47], v[16:19], v[116:119]
  ds_read_b64_tr_b16 v[80:81], v12 offset:9312
  v_mfma_f32_16x16x32_bf16 v[152:155], v[44:47], v[20:23], v[152:155]
  ds_read_b64_tr_b16 v[82:83], v12 offset:10464
  v_mfma_f32_16x16x32_bf16 v[120:123], v[48:51], v[16:19], v[120:123]
  ds_read_b64_tr_b16 v[84:85], v12 offset:9344
  v_mfma_f32_16x16x32_bf16 v[156:159], v[48:51], v[20:23], v[156:159]
  ds_read_b64_tr_b16 v[86:87], v12 offset:10496
  v_mfma_f32_16x16x32_bf16 v[124:127], v[52:55], v[16:19], v[124:127]
  ds_read_b64_tr_b16 v[88:89], v13 offset:9376
  v_mfma_f32_16x16x32_bf16 v[160:163], v[52:55], v[20:23], v[160:163]
  ds_read_b64_tr_b16 v[90:91], v13 offset:10528
  v_mfma_f32_16x16x32_bf16 v[128:131], v[56:59], v[16:19], v[128:131]
  ds_read_b64_tr_b16 v[92:93], v13 offset:9408
  v_mfma_f32_16x16x32_bf16 v[164:167], v[56:59], v[20:23], v[164:167]
  ds_read_b64_tr_b16 v[94:95], v13 offset:10560
  v_mfma_f32_16x16x32_bf16 v[132:135], v[60:63], v[16:19], v[132:135]
  ds_read_b64_tr_b16 v[96:97], v13 offset:9440
  v_mfma_f32_16x16x32_bf16 v[168:171], v[60:63], v[20:23], v[168:171]
  ds_read_b64_tr_b16 v[98:99], v13 offset:10592
  v_mfma_f32_16x16x32_bf16 v[136:139], v[64:67], v[16:19], v[136:139]
  ds_read_b64_tr_b16 v[100:101], v13 offset:9472
  v_mfma_f32_16x16x32_bf16 v[172:175], v[64:67], v[20:23], v[172:175]
  ds_read_b64_tr_b16 v[102:103], v13 offset:10624
  s_cmp_eq_u32 s27, 8
  s_cbranch_scc1 L_k1_last_13
  s_add_u32 s29, s29, 34816
  s_cmp_ge_u32 s29, 139264
  s_cselect_b32 s29, 0, s29
  v_add_u32 v8, s29, v6
  s_waitcnt lgkmcnt(0)
  v_add_u32 v12, s29, v10
  v_add_u32 v13, s29, v11
  s_barrier
  v_mfma_f32_16x16x32_bf16 v[104:107], v[68:71], v[24:27], v[104:107]
  ds_read_b128 v[16:19], v8 offset:0
  ds_read_b128 v[20:23], v8 offset:2048
  v_mfma_f32_16x16x32_bf16 v[140:143], v[68:71], v[28:31], v[140:143]
  ds_read_b64_tr_b16 v[32:33], v12 offset:0
  ds_read_b64_tr_b16 v[34:35], v12 offset:1152
  v_mfma_f32_16x16x32_bf16 v[108:111], v[72:75], v[24:27], v[108:111]
  ds_read_b64_tr_b16 v[36:37], v12 offset:32
  v_mfma_f32_16x16x32_bf16 v[144:147], v[72:75], v[28:31], v[144:147]
  ds_read_b64_tr_b16 v[38:39], v12 offset:1184
  v_mfma_f32_16x16x32_bf16 v[112:115], v[76:79], v[24:27], v[112:115]
  ds_read_b64_tr_b16 v[40:41], v12 offset:64
  v_mfma_f32_16x16x32_bf16 v[148:151], v[76:79], v[28:31], v[148:151]
  ds_read_b64_tr_b16 v[42:43], v12 offset:1216
  v_mfma_f32_16x16x32_bf16 v[116:119], v[80:83], v[24:27], v[116:119]
  ds_read_b64_tr_b16 v[44:45], v12 offset:96
  v_mfma_f32_16x16x32_bf16 v[152:155], v[80:83], v[28:31], v[152:155]
  ds_read_b64_tr_b16 v[46:47], v12 offset:1248
  v_mfma_f32_16x16x32_bf16 v[120:123], v[84:87], v[24:27], v[120:123]
  ds_read_b64_tr_b16 v[48:49], v12 offset:128
  v_mfma_f32_16x16x32_bf16 v[156:159], v[84:87], v[28:31], v[156:159]
  ds_read_b64_tr_b16 v[50:51], v12 offset:1280
  v_mfma_f32_16x16x32_bf16 v[124:127], v[88:91], v[24:27], v[124:127]
  ds_read_b64_tr_b16 v[52:53], v13 offset:160
  v_mfma_f32_16x16x32_bf16 v[160:163], v[88:91], v[28:31], v[160:163]
  ds_read_b64_tr_b16 v[54:55], v13 offset:1312
  v_mfma_f32_16x16x32_bf16 v[128:131], v[92:95], v[24:27], v[128:131]
  ds_read_b64_tr_b16 v[56:57], v13 offset:192
  v_mfma_f32_16x16x32_bf16 v[164:167], v[92:95], v[28:31], v[164:167]
  ds_read_b64_tr_b16 v[58:59], v13 offset:1344
  v_mfma_f32_16x16x32_bf16 v[132:135], v[96:99], v[24:27], v[132:135]
  ds_read_b64_tr_b16 v[60:61], v13 offset:224
  v_mfma_f32_16x16x32_bf16 v[168:171], v[96:99], v[28:31], v[168:171]
  ds_read_b64_tr_b16 v[62:63], v13 offset:1376
  v_mfma_f32_16x16x32_bf16 v[136:139], v[100:103], v[24:27], v[136:139]
  ds_read_b64_tr_b16 v[64:65], v13 offset:256
  v_mfma_f32_16x16x32_bf16 v[172:175], v[100:103], v[28:31], v[172:175]
  ds_read_b64_tr_b16 v[66:67], v13 offset:1408
  v_add_u32 v9, s29, v7
  s_add_u32 s27, s27, 1
  s_branch L_k1_loop_12
L_k1_last_13:
  s_waitcnt lgkmcnt(0)
  v_mfma_f32_16x16x32_bf16 v[104:107], v[68:71], v[24:27], v[104:107]
  v_mfma_f32_16x16x32_bf16 v[140:143], v[68:71], v[28:31], v[140:143]
  v_mfma_f32_16x16x32_bf16 v[108:111], v[72:75], v[24:27], v[108:111]
  v_mfma_f32_16x16x32_bf16 v[144:147], v[72:75], v[28:31], v[144:147]
  v_mfma_f32_16x16x32_bf16 v[112:115], v[76:79], v[24:27], v[112:115]
  v_mfma_f32_16x16x32_bf16 v[148:151], v[76:79], v[28:31], v[148:151]
  v_mfma_f32_16x16x32_bf16 v[116:119], v[80:83], v[24:27], v[116:119]
  v_mfma_f32_16x16x32_bf16 v[152:155], v[80:83], v[28:31], v[152:155]
  v_mfma_f32_16x16x32_bf16 v[120:123], v[84:87], v[24:27], v[120:123]
  v_mfma_f32_16x16x32_bf16 v[156:159], v[84:87], v[28:31], v[156:159]
  v_mfma_f32_16x16x32_bf16 v[124:127], v[88:91], v[24:27], v[124:127]
  v_mfma_f32_16x16x32_bf16 v[160:163], v[88:91], v[28:31], v[160:163]
  v_mfma_f32_16x16x32_bf16 v[128:131], v[92:95], v[24:27], v[128:131]
  v_mfma_f32_16x16x32_bf16 v[164:167], v[92:95], v[28:31], v[164:167]
  v_mfma_f32_16x16x32_bf16 v[132:135], v[96:99], v[24:27], v[132:135]
  v_mfma_f32_16x16x32_bf16 v[168:171], v[96:99], v[28:31], v[168:171]
  v_mfma_f32_16x16x32_bf16 v[136:139], v[100:103], v[24:27], v[136:139]
  v_mfma_f32_16x16x32_bf16 v[172:175], v[100:103], v[28:31], v[172:175]
  s_branch L_k1_epi_2
L_k1_v_11:
  ds_read_b128 v[16:19], v8 offset:0
  ds_read_b128 v[20:23], v8 offset:2048
  ds_read_b64_tr_b16 v[32:33], v12 offset:0
  ds_read_b64_tr_b16 v[34:35], v12 offset:1152
  ds_read_b64_tr_b16 v[36:37], v12 offset:32
  ds_read_b64_tr_b16 v[38:39], v12 offset:1184
  ds_read_b64_tr_b16 v[40:41], v12 offset:64
  ds_read_b64_tr_b16 v[42:43], v12 offset:1216
  ds_read_b64_tr_b16 v[44:45], v12 offset:96
  ds_read_b64_tr_b16 v[46:47], v12 offset:1248
  ds_read_b64_tr_b16 v[48:49], v12 offset:128
  ds_read_b64_tr_b16 v[50:51], v12 offset:1280
  ds_read_b64_tr_b16 v[52:53], v13 offset:160
  ds_read_b64_tr_b16 v[54:55], v13 offset:1312
  ds_read_b64_tr_b16 v[56:57], v13 offset:192
  ds_read_b64_tr_b16 v[58:59], v13 offset:1344
  ds_read_b64_tr_b16 v[60:61], v13 offset:224
  ds_read_b64_tr_b16 v[62:63], v13 offset:1376
  ds_read_b64_tr_b16 v[64:65], v13 offset:256
  ds_read_b64_tr_b16 v[66:67], v13 offset:1408
L_k1_loop_14:
  s_waitcnt lgkmcnt(0)
  v_mfma_f32_16x16x32_bf16 v[104:107], v[16:19], v[32:35], v[104:107]
  ds_read_b128 v[24:27], v9 offset:0
  ds_read_b128 v[28:31], v9 offset:2048
  v_mfma_f32_16x16x32_bf16 v[140:143], v[20:23], v[32:35], v[140:143]
  ds_read_b64_tr_b16 v[68:69], v12 offset:9216
  ds_read_b64_tr_b16 v[70:71], v12 offset:10368
  v_mfma_f32_16x16x32_bf16 v[108:111], v[16:19], v[36:39], v[108:111]
  ds_read_b64_tr_b16 v[72:73], v12 offset:9248
  v_mfma_f32_16x16x32_bf16 v[144:147], v[20:23], v[36:39], v[144:147]
  ds_read_b64_tr_b16 v[74:75], v12 offset:10400
  v_mfma_f32_16x16x32_bf16 v[112:115], v[16:19], v[40:43], v[112:115]
  ds_read_b64_tr_b16 v[76:77], v12 offset:9280
  v_mfma_f32_16x16x32_bf16 v[148:151], v[20:23], v[40:43], v[148:151]
  ds_read_b64_tr_b16 v[78:79], v12 offset:10432
  v_mfma_f32_16x16x32_bf16 v[116:119], v[16:19], v[44:47], v[116:119]
  ds_read_b64_tr_b16 v[80:81], v12 offset:9312
  v_mfma_f32_16x16x32_bf16 v[152:155], v[20:23], v[44:47], v[152:155]
  ds_read_b64_tr_b16 v[82:83], v12 offset:10464
  v_mfma_f32_16x16x32_bf16 v[120:123], v[16:19], v[48:51], v[120:123]
  ds_read_b64_tr_b16 v[84:85], v12 offset:9344
  v_mfma_f32_16x16x32_bf16 v[156:159], v[20:23], v[48:51], v[156:159]
  ds_read_b64_tr_b16 v[86:87], v12 offset:10496
  v_mfma_f32_16x16x32_bf16 v[124:127], v[16:19], v[52:55], v[124:127]
  ds_read_b64_tr_b16 v[88:89], v13 offset:9376
  v_mfma_f32_16x16x32_bf16 v[160:163], v[20:23], v[52:55], v[160:163]
  ds_read_b64_tr_b16 v[90:91], v13 offset:10528
  v_mfma_f32_16x16x32_bf16 v[128:131], v[16:19], v[56:59], v[128:131]
  ds_read_b64_tr_b16 v[92:93], v13 offset:9408
  v_mfma_f32_16x16x32_bf16 v[164:167], v[20:23], v[56:59], v[164:167]
  ds_read_b64_tr_b16 v[94:95], v13 offset:10560
  v_mfma_f32_16x16x32_bf16 v[132:135], v[16:19], v[60:63], v[132:135]
  ds_read_b64_tr_b16 v[96:97], v13 offset:9440
  v_mfma_f32_16x16x32_bf16 v[168:171], v[20:23], v[60:63], v[168:171]
  ds_read_b64_tr_b16 v[98:99], v13 offset:10592
  v_mfma_f32_16x16x32_bf16 v[136:139], v[16:19], v[64:67], v[136:139]
  ds_read_b64_tr_b16 v[100:101], v13 offset:9472
  v_mfma_f32_16x16x32_bf16 v[172:175], v[20:23], v[64:67], v[172:175]
  ds_read_b64_tr_b16 v[102:103], v13 offset:10624
  s_cmp_eq_u32 s27, 8
  s_cbranch_scc1 L_k1_last_15
  s_add_u32 s29, s29, 34816
  s_cmp_ge_u32 s29, 139264
  s_cselect_b32 s29, 0, s29
  v_add_u32 v8, s29, v6
  s_waitcnt lgkmcnt(0)
  v_add_u32 v12, s29, v10
  v_add_u32 v13, s29, v11
  s_barrier
  v_mfma_f32_16x16x32_bf16 v[104:107], v[24:27], v[68:71], v[104:107]
  ds_read_b128 v[16:19], v8 offset:0
  ds_read_b128 v[20:23], v8 offset:2048
  v_mfma_f32_16x16x32_bf16 v[140:143], v[28:31], v[68:71], v[140:143]
  ds_read_b64_tr_b16 v[32:33], v12 offset:0
  ds_read_b64_tr_b16 v[34:35], v12 offset:1152
  v_mfma_f32_16x16x32_bf16 v[108:111], v[24:27], v[72:75], v[108:111]
  ds_read_b64_tr_b16 v[36:37], v12 offset:32
  v_mfma_f32_16x16x32_bf16 v[144:147], v[28:31], v[72:75], v[144:147]
  ds_read_b64_tr_b16 v[38:39], v12 offset:1184
  v_mfma_f32_16x16x32_bf16 v[112:115], v[24:27], v[76:79], v[112:115]
  ds_read_b64_tr_b16 v[40:41], v12 offset:64
  v_mfma_f32_16x16x32_bf16 v[148:151], v[28:31], v[76:79], v[148:151]
  ds_read_b64_tr_b16 v[42:43], v12 offset:1216
  v_mfma_f32_16x16x32_bf16 v[116:119], v[24:27], v[80:83], v[116:119]
  ds_read_b64_tr_b16 v[44:45], v12 offset:96
  v_mfma_f32_16x16x32_bf16 v[152:155], v[28:31], v[80:83], v[152:155]
  ds_read_b64_tr_b16 v[46:47], v12 offset:1248
  v_mfma_f32_16x16x32_bf16 v[120:123], v[24:27], v[84:87], v[120:123]
  ds_read_b64_tr_b16 v[48:49], v12 offset:128
  v_mfma_f32_16x16x32_bf16 v[156:159], v[28:31], v[84:87], v[156:159]
  ds_read_b64_tr_b16 v[50:51], v12 offset:1280
  v_mfma_f32_16x16x32_bf16 v[124:127], v[24:27], v[88:91], v[124:127]
  ds_read_b64_tr_b16 v[52:53], v13 offset:160
  v_mfma_f32_16x16x32_bf16 v[160:163], v[28:31], v[88:91], v[160:163]
  ds_read_b64_tr_b16 v[54:55], v13 offset:1312
  v_mfma_f32_16x16x32_bf16 v[128:131], v[24:27], v[92:95], v[128:131]
  ds_read_b64_tr_b16 v[56:57], v13 offset:192
  v_mfma_f32_16x16x32_bf16 v[164:167], v[28:31], v[92:95], v[164:167]
  ds_read_b64_tr_b16 v[58:59], v13 offset:1344
  v_mfma_f32_16x16x32_bf16 v[132:135], v[24:27], v[96:99], v[132:135]
  ds_read_b64_tr_b16 v[60:61], v13 offset:224
  v_mfma_f32_16x16x32_bf16 v[168:171], v[28:31], v[96:99], v[168:171]
  ds_read_b64_tr_b16 v[62:63], v13 offset:1376
  v_mfma_f32_16x16x32_bf16 v[136:139], v[24:27], v[100:103], v[136:139]
  ds_read_b64_tr_b16 v[64:65], v13 offset:256
  v_mfma_f32_16x16x32_bf16 v[172:175], v[28:31], v[100:103], v[172:175]
  ds_read_b64_tr_b16 v[66:67], v13 offset:1408
  v_add_u32 v9, s29, v7
  s_add_u32 s27, s27, 1
  s_branch L_k1_loop_14
L_k1_last_15:
  s_waitcnt lgkmcnt(0)
  v_mfma_f32_16x16x32_bf16 v[104:107], v[24:27], v[68:71], v[104:107]
  v_mfma_f32_16x16x32_bf16 v[140:143], v[28:31], v[68:71], v[140:143]
  v_mfma_f32_16x16x32_bf16 v[108:111], v[24:27], v[72:75], v[108:111]
  v_mfma_f32_16x16x32_bf16 v[144:147], v[28:31], v[72:75], v[144:147]
  v_mfma_f32_16x16x32_bf16 v[112:115], v[24:27], v[76:79], v[112:115]
  v_mfma_f32_16x16x32_bf16 v[148:151], v[28:31], v[76:79], v[148:151]
  v_mfma_f32_16x16x32_bf16 v[116:119], v[24:27], v[80:83], v[116:119]
  v_mfma_f32_16x16x32_bf16 v[152:155], v[28:31], v[80:83], v[152:155]
  v_mfma_f32_16x16x32_bf16 v[120:123], v[24:27], v[84:87], v[120:123]
  v_mfma_f32_16x16x32_bf16 v[156:159], v[28:31], v[84:87], v[156:159]
  v_mfma_f32_16x16x32_bf16 v[124:127], v[24:27], v[88:91], v[124:127]
  v_mfma_f32_16x16x32_bf16 v[160:163], v[28:31], v[88:91], v[160:163]
  v_mfma_f32_16x16x32_bf16 v[128:131], v[24:27], v[92:95], v[128:131]
  v_mfma_f32_16x16x32_bf16 v[164:167], v[28:31], v[92:95], v[164:167]
  v_mfma_f32_16x16x32_bf16 v[132:135], v[24:27], v[96:99], v[132:135]
  v_mfma_f32_16x16x32_bf16 v[168:171], v[28:31], v[96:99], v[168:171]
  v_mfma_f32_16x16x32_bf16 v[136:139], v[24:27], v[100:103], v[136:139]
  v_mfma_f32_16x16x32_bf16 v[172:175], v[28:31], v[100:103], v[172:175]
  s_branch L_k1_epi_2
L_k1_epi_2:
  s_nop 7
  s_barrier
  s_cmp_eq_u32 s23, 2
  s_cbranch_scc1 L_k1_epi_v_16
  s_cmp_eq_u32 s23, 0
  s_cselect_b32 s38, 0x3eae1a93, 1.0
  v_mul_f32 v104, s38, v104
  v_mul_f32 v105, s38, v105
  v_mul_f32 v106, s38, v106
  v_mul_f32 v107, s38, v107
  v_cvt_pk_bf16_f32 v104, v104, v105
  v_cvt_pk_bf16_f32 v106, v106, v107
  ds_write_b32 v176, v104
  ds_write_b32 v177, v106
  v_mul_f32 v140, s38, v140
  v_mul_f32 v141, s38, v141
  v_mul_f32 v142, s38, v142
  v_mul_f32 v143, s38, v143
  v_cvt_pk_bf16_f32 v140, v140, v141
  v_cvt_pk_bf16_f32 v142, v142, v143
  ds_write_b32 v194, v140
  ds_write_b32 v195, v142
  v_mul_f32 v108, s38, v108
  v_mul_f32 v109, s38, v109
  v_mul_f32 v110, s38, v110
  v_mul_f32 v111, s38, v111
  v_cvt_pk_bf16_f32 v108, v108, v109
  v_cvt_pk_bf16_f32 v110, v110, v111
  ds_write_b32 v178, v108
  ds_write_b32 v179, v110
  v_mul_f32 v144, s38, v144
  v_mul_f32 v145, s38, v145
  v_mul_f32 v146, s38, v146
  v_mul_f32 v147, s38, v147
  v_cvt_pk_bf16_f32 v144, v144, v145
  v_cvt_pk_bf16_f32 v146, v146, v147
  ds_write_b32 v196, v144
  ds_write_b32 v197, v146
  v_mul_f32 v112, s38, v112
  v_mul_f32 v113, s38, v113
  v_mul_f32 v114, s38, v114
  v_mul_f32 v115, s38, v115
  v_cvt_pk_bf16_f32 v112, v112, v113
  v_cvt_pk_bf16_f32 v114, v114, v115
  ds_write_b32 v180, v112
  ds_write_b32 v181, v114
  v_mul_f32 v148, s38, v148
  v_mul_f32 v149, s38, v149
  v_mul_f32 v150, s38, v150
  v_mul_f32 v151, s38, v151
  v_cvt_pk_bf16_f32 v148, v148, v149
  v_cvt_pk_bf16_f32 v150, v150, v151
  ds_write_b32 v198, v148
  ds_write_b32 v199, v150
  v_mul_f32 v116, s38, v116
  v_mul_f32 v117, s38, v117
  v_mul_f32 v118, s38, v118
  v_mul_f32 v119, s38, v119
  v_cvt_pk_bf16_f32 v116, v116, v117
  v_cvt_pk_bf16_f32 v118, v118, v119
  ds_write_b32 v182, v116
  ds_write_b32 v183, v118
  v_mul_f32 v152, s38, v152
  v_mul_f32 v153, s38, v153
  v_mul_f32 v154, s38, v154
  v_mul_f32 v155, s38, v155
  v_cvt_pk_bf16_f32 v152, v152, v153
  v_cvt_pk_bf16_f32 v154, v154, v155
  ds_write_b32 v200, v152
  ds_write_b32 v201, v154
  v_mul_f32 v120, s38, v120
  v_mul_f32 v121, s38, v121
  v_mul_f32 v122, s38, v122
  v_mul_f32 v123, s38, v123
  v_cvt_pk_bf16_f32 v120, v120, v121
  v_cvt_pk_bf16_f32 v122, v122, v123
  ds_write_b32 v184, v120
  ds_write_b32 v185, v122
  v_mul_f32 v156, s38, v156
  v_mul_f32 v157, s38, v157
  v_mul_f32 v158, s38, v158
  v_mul_f32 v159, s38, v159
  v_cvt_pk_bf16_f32 v156, v156, v157
  v_cvt_pk_bf16_f32 v158, v158, v159
  ds_write_b32 v202, v156
  ds_write_b32 v203, v158
  v_mul_f32 v124, s38, v124
  v_mul_f32 v125, s38, v125
  v_mul_f32 v126, s38, v126
  v_mul_f32 v127, s38, v127
  v_cvt_pk_bf16_f32 v124, v124, v125
  v_cvt_pk_bf16_f32 v126, v126, v127
  ds_write_b32 v186, v124
  ds_write_b32 v187, v126
  v_mul_f32 v160, s38, v160
  v_mul_f32 v161, s38, v161
  v_mul_f32 v162, s38, v162
  v_mul_f32 v163, s38, v163
  v_cvt_pk_bf16_f32 v160, v160, v161
  v_cvt_pk_bf16_f32 v162, v162, v163
  ds_write_b32 v204, v160
  ds_write_b32 v205, v162
  v_mul_f32 v128, s38, v128
  v_mul_f32 v129, s38, v129
  v_mul_f32 v130, s38, v130
  v_mul_f32 v131, s38, v131
  v_cvt_pk_bf16_f32 v128, v128, v129
  v_cvt_pk_bf16_f32 v130, v130, v131
  ds_write_b32 v188, v128
  ds_write_b32 v189, v130
  v_mul_f32 v164, s38, v164
  v_mul_f32 v165, s38, v165
  v_mul_f32 v166, s38, v166
  v_mul_f32 v167, s38, v167
  v_cvt_pk_bf16_f32 v164, v164, v165
  v_cvt_pk_bf16_f32 v166, v166, v167
  ds_write_b32 v206, v164
  ds_write_b32 v207, v166
  v_mul_f32 v132, s38, v132
  v_mul_f32 v133, s38, v133
  v_mul_f32 v134, s38, v134
  v_mul_f32 v135, s38, v135
  v_cvt_pk_bf16_f32 v132, v132, v133
  v_cvt_pk_bf16_f32 v134, v134, v135
  ds_write_b32 v190, v132
  ds_write_b32 v191, v134
  v_mul_f32 v168, s38, v168
  v_mul_f32 v169, s38, v169
  v_mul_f32 v170, s38, v170
  v_mul_f32 v171, s38, v171
  v_cvt_pk_bf16_f32 v168, v168, v169
  v_cvt_pk_bf16_f32 v170, v170, v171
  ds_write_b32 v208, v168
  ds_write_b32 v209, v170
  v_mul_f32 v136, s38, v136
  v_mul_f32 v137, s38, v137
  v_mul_f32 v138, s38, v138
  v_mul_f32 v139, s38, v139
  v_cvt_pk_bf16_f32 v136, v136, v137
  v_cvt_pk_bf16_f32 v138, v138, v139
  ds_write_b32 v192, v136
  ds_write_b32 v193, v138
  v_mul_f32 v172, s38, v172
  v_mul_f32 v173, s38, v173
  v_mul_f32 v174, s38, v174
  v_mul_f32 v175, s38, v175
  v_cvt_pk_bf16_f32 v172, v172, v173
  v_cvt_pk_bf16_f32 v174, v174, v175
  ds_write_b32 v210, v172
  ds_write_b32 v211, v174
  v_mov_b32 v12, v217
  v_mov_b32 v13, v218
  v_mov_b32 v14, v219
  v_mov_b32 v15, v220
  v_mov_b32 v16, v221
  s_branch L_k1_co_17
L_k1_epi_v_16:
  v_cvt_pk_bf16_f32 v104, v104, v105
  v_cvt_pk_bf16_f32 v105, v106, v107
  ds_write_b64 v176, v[104:105] offset:0
  v_cvt_pk_bf16_f32 v140, v140, v141
  v_cvt_pk_bf16_f32 v141, v142, v143
  ds_write_b64 v176, v[140:141] offset:640
  v_cvt_pk_bf16_f32 v108, v108, v109
  v_cvt_pk_bf16_f32 v109, v110, v111
  ds_write_b64 v178, v[108:109] offset:0
  v_cvt_pk_bf16_f32 v144, v144, v145
  v_cvt_pk_bf16_f32 v145, v146, v147
  ds_write_b64 v178, v[144:145] offset:640
  v_cvt_pk_bf16_f32 v112, v112, v113
  v_cvt_pk_bf16_f32 v113, v114, v115
  ds_write_b64 v180, v[112:113] offset:0
  v_cvt_pk_bf16_f32 v148, v148, v149
  v_cvt_pk_bf16_f32 v149, v150, v151
  ds_write_b64 v180, v[148:149] offset:640
  v_cvt_pk_bf16_f32 v116, v116, v117
  v_cvt_pk_bf16_f32 v117, v118, v119
  ds_write_b64 v182, v[116:117] offset:0
  v_cvt_pk_bf16_f32 v152, v152, v153
  v_cvt_pk_bf16_f32 v153, v154, v155
  ds_write_b64 v182, v[152:153] offset:640
  v_cvt_pk_bf16_f32 v120, v120, v121
  v_cvt_pk_bf16_f32 v121, v122, v123
  ds_write_b64 v184, v[120:121] offset:0
  v_cvt_pk_bf16_f32 v156, v156, v157
  v_cvt_pk_bf16_f32 v157, v158, v159
  ds_write_b64 v184, v[156:157] offset:640
  v_cvt_pk_bf16_f32 v124, v124, v125
  v_cvt_pk_bf16_f32 v125, v126, v127
  ds_write_b64 v186, v[124:125] offset:0
  v_cvt_pk_bf16_f32 v160, v160, v161
  v_cvt_pk_bf16_f32 v161, v162, v163
  ds_write_b64 v186, v[160:161] offset:640
  v_cvt_pk_bf16_f32 v128, v128, v129
  v_cvt_pk_bf16_f32 v129, v130, v131
  ds_write_b64 v188, v[128:129] offset:0
  v_cvt_pk_bf16_f32 v164, v164, v165
  v_cvt_pk_bf16_f32 v165, v166, v167
  ds_write_b64 v188, v[164:165] offset:640
  v_cvt_pk_bf16_f32 v132, v132, v133
  v_cvt_pk_bf16_f32 v133, v134, v135
  ds_write_b64 v190, v[132:133] offset:0
  v_cvt_pk_bf16_f32 v168, v168, v169
  v_cvt_pk_bf16_f32 v169, v170, v171
  ds_write_b64 v190, v[168:169] offset:640
  v_cvt_pk_bf16_f32 v136, v136, v137
  v_cvt_pk_bf16_f32 v137, v138, v139
  ds_write_b64 v192, v[136:137] offset:0
  v_cvt_pk_bf16_f32 v172, v172, v173
  v_cvt_pk_bf16_f32 v173, v174, v175
  ds_write_b64 v192, v[172:173] offset:640
  v_mov_b32 v12, v217
  v_mov_b32 v13, v218
  v_mov_b32 v14, v219
  v_mov_b32 v15, v220
  v_mov_b32 v16, v221
  s_branch L_k1_co_17
L_k1_loader_1:
  s_sub_u32 s24, s20, 4
  v_lshrrev_b32 v2, 4, v1
  s_and_b32 s38, s24, 1
  s_lshl_b32 s38, s38, 2
  v_add_u32 v2, s38, v2
  v_and_b32 v3, 7, v1
  v_xor_b32 v2, v2, v3
  v_lshlrev_b32 v2, 4, v2
  v_lshrrev_b32 v3, 3, v1
  v_mul_u32_u24 v3, 1152, v3
  v_add_u32 v6, v2, v3
  s_lshl_b32 s40, s21, 7
  s_lshl_b32 s38, s24, 3
  s_add_u32 s40, s40, s38
  s_mul_i32 s40, s40, 1152
  s_add_u32 s41, s40, 36864
  s_add_u32 s42, s40, 73728
  s_add_u32 s43, s40, 110592
  s_lshl_b32 s38, s24, 4
  s_mul_i32 s44, s38, 3456
  s_mul_i32 s39, s22, 288
  s_add_u32 s44, s44, s39
  s_lshl_b32 s45, s24, 10
  s_mul_i32 s46, s24, 4608
  s_add_u32 s46, s46, 16384
  s_mov_b32 s28, 0
  s_add_u32 m0, s28, s45
  s_add_u32 m0, m0, 0
  s_nop 0
  buffer_load_dwordx4 v6, s[8:11], s40 offen lds
  s_add_u32 s40, s40, 128
  s_add_u32 m0, s28, s45
  s_add_u32 m0, m0, 4096
  s_nop 0
  buffer_load_dwordx4 v6, s[8:11], s41 offen lds
  s_add_u32 s41, s41, 128
  s_add_u32 m0, s28, s45
  s_add_u32 m0, m0, 8192
  s_nop 0
  buffer_load_dwordx4 v6, s[8:11], s42 offen lds
  s_add_u32 s42, s42, 128
  s_add_u32 m0, s28, s45
  s_add_u32 m0, m0, 12288
  s_nop 0
  buffer_load_dwordx4 v6, s[8:11], s43 offen lds
  s_add_u32 s43, s43, 128
  v_add_u32 v2, 0, v1
  v_mul_u32_u24 v3, 3641, v2
  v_lshrrev_b32 v3, 16, v3
  v_mul_u32_u24 v4, 18, v3
  v_sub_u32 v4, v2, v4
  v_and_b32 v5, 8, v3
  v_sub_u32 v4, v4, v5
  v_add_u32 v5, 18, v4
  v_min_u32 v4, v4, v5
  v_lshlrev_b32 v4, 4, v4
  v_mul_u32_u24 v3, 3456, v3
  v_add_u32 v7, v3, v4
  v_add_u32 v2, 64, v1
  v_mul_u32_u24 v3, 3641, v2
  v_lshrrev_b32 v3, 16, v3
  v_mul_u32_u24 v4, 18, v3
  v_sub_u32 v4, v2, v4
  v_and_b32 v5, 8, v3
  v_sub_u32 v4, v4, v5
  v_add_u32 v5, 18, v4
  v_min_u32 v4, v4, v5
  v_lshlrev_b32 v4, 4, v4
  v_mul_u32_u24 v3, 3456, v3
  v_add_u32 v8, v3, v4
  v_add_u32 v2, 128, v1
  v_mul_u32_u24 v3, 3641, v2
  v_lshrrev_b32 v3, 16, v3
  v_mul_u32_u24 v4, 18, v3
  v_sub_u32 v4, v2, v4
  v_and_b32 v5, 8, v3
  v_sub_u32 v4, v4, v5
  v_add_u32 v5, 18, v4
  v_min_u32 v4, v4, v5
  v_lshlrev_b32 v4, 4, v4
  v_mul_u32_u24 v3, 3456, v3
  v_add_u32 v9, v3, v4
  v_add_u32 v2, 192, v1
  v_mul_u32_u24 v3, 3641, v2
  v_lshrrev_b32 v3, 16, v3
  v_mul_u32_u24 v4, 18, v3
  v_sub_u32 v4, v2, v4
  v_and_b32 v5, 8, v3
  v_sub_u32 v4, v4, v5
  v_add_u32 v5, 18, v4
  v_min_u32 v4, v4, v5
  v_lshlrev_b32 v4, 4, v4
  v_mul_u32_u24 v3, 3456, v3
  v_add_u32 v10, v3, v4
  v_add_u32 v2, 256, v1
  v_mul_u32_u24 v3, 3641, v2
  v_lshrrev_b32 v3, 16, v3
  v_mul_u32_u24 v4, 18, v3
  v_sub_u32 v4, v2, v4
  v_and_b32 v5, 8, v3
  v_sub_u32 v4, v4, v5
  v_add_u32 v5, 18, v4
  v_min_u32 v4, v4, v5
  v_lshlrev_b32 v4, 4, v4
  v_mul_u32_u24 v3, 3456, v3
  v_add_u32 v11, v3, v4
  s_add_u32 m0, s28, s46
  s_nop 0
  buffer_load_dwordx4 v7, s[12:15], s44 offen lds
  s_add_u32 m0, m0, 1024
  s_nop 0
  buffer_load_dwordx4 v8, s[12:15], s44 offen lds
  s_add_u32 m0, m0, 1024
  s_nop 0
  buffer_load_dwordx4 v9, s[12:15], s44 offen lds
  s_add_u32 m0, m0, 1024
  s_nop 0
  buffer_load_dwordx4 v10, s[12:15], s44 offen lds
  s_add_u32 m0, m0, 1024
  s_mov_b32 exec_hi, 0
  buffer_load_dwordx4 v11, s[12:15], s44 offen lds
  s_mov_b64 exec, -1
  s_add_u32 s44, s44, 221184
  s_add_u32 s28, s28, 34816
  s_cmp_ge_u32 s28, 139264
  s_cselect_b32 s28, 0, s28
  s_add_u32 m0, s28, s45
  s_add_u32 m0, m0, 0
  s_nop 0
  buffer_load_dwordx4 v6, s[8:11], s40 offen lds
  s_add_u32 s40, s40, 128
  s_add_u32 m0, s28, s45
  s_add_u32 m0, m0, 4096
  s_nop 0
  buffer_load_dwordx4 v6, s[8:11], s41 offen lds
  s_add_u32 s41, s41, 128
  s_add_u32 m0, s28, s45
  s_add_u32 m0, m0, 8192
  s_nop 0
  buffer_load_dwordx4 v6, s[8:11], s42 offen lds
  s_add_u32 s42, s42, 128
  s_add_u32 m0, s28, s45
  s_add_u32 m0, m0, 12288
  s_nop 0
  buffer_load_dwordx4 v6, s[8:11], s43 offen lds
  s_add_u32 s43, s43, 128
  s_add_u32 m0, s28, s46
  s_nop 0
  buffer_load_dwordx4 v7, s[12:15], s44 offen lds
  s_add_u32 m0, m0, 1024
  s_nop 0
  buffer_load_dwordx4 v8, s[12:15], s44 offen lds
  s_add_u32 m0, m0, 1024
  s_nop 0
  buffer_load_dwordx4 v9, s[12:15], s44 offen lds
  s_add_u32 m0, m0, 1024
  s_nop 0
  buffer_load_dwordx4 v10, s[12:15], s44 offen lds
  s_add_u32 m0, m0, 1024
  s_mov_b32 exec_hi, 0
  buffer_load_dwordx4 v11, s[12:15], s44 offen lds
  s_mov_b64 exec, -1
  s_add_u32 s44, s44, 221184
  s_add_u32 s28, s28, 34816
  s_cmp_ge_u32 s28, 139264
  s_cselect_b32 s28, 0, s28
  s_waitcnt vmcnt(9)
  s_barrier
  s_add_u32 m0, s28, s45
  s_add_u32 m0, m0, 0
  s_nop 0
  buffer_load_dwordx4 v6, s[8:11], s40 offen lds
  s_add_u32 s40, s40, 128
  s_add_u32 m0, s28, s45
  s_add_u32 m0, m0, 4096
  s_nop 0
  buffer_load_dwordx4 v6, s[8:11], s41 offen lds
  s_add_u32 s41, s41, 128
  s_add_u32 m0, s28, s45
  s_add_u32 m0, m0, 8192
  s_nop 0
  buffer_load_dwordx4 v6, s[8:11], s42 offen lds
  s_add_u32 s42, s42, 128
  s_add_u32 m0, s28, s45
  s_add_u32 m0, m0, 12288
  s_nop 0
  buffer_load_dwordx4 v6, s[8:11], s43 offen lds
  s_add_u32 s43, s43, 128
  s_add_u32 m0, s28, s46
  s_nop 0
  buffer_load_dwordx4 v7, s[12:15], s44 offen lds
  s_add_u32 m0, m0, 1024
  s_nop 0
  buffer_load_dwordx4 v8, s[12:15], s44 offen lds
  s_add_u32 m0, m0, 1024
  s_nop 0
  buffer_load_dwordx4 v9, s[12:15], s44 offen lds
  s_add_u32 m0, m0, 1024
  s_nop 0
  buffer_load_dwordx4 v10, s[12:15], s44 offen lds
  s_add_u32 m0, m0, 1024
  s_mov_b32 exec_hi, 0
  buffer_load_dwordx4 v11, s[12:15], s44 offen lds
  s_mov_b64 exec, -1
  s_add_u32 s44, s44, 221184
  s_add_u32 s28, s28, 34816
  s_cmp_ge_u32 s28, 139264
  s_cselect_b32 s28, 0, s28
  s_mov_b32 s27, 0
L_k1_ll_21:
  s_cmp_gt_u32 s27, 6
  s_cbranch_scc0 L_k1_lw_22
  s_waitcnt vmcnt(0)
L_k1_lw_22:
  s_waitcnt vmcnt(9)
  s_barrier
  s_cmp_ge_u32 s27, 6
  s_cbranch_scc1 L_k1_lt_23
  s_add_u32 m0, s28, s45
  s_add_u32 m0, m0, 0
  s_nop 0
  buffer_load_dwordx4 v6, s[8:11], s40 offen lds
  s_add_u32 s40, s40, 128
  s_add_u32 m0, s28, s45
  s_add_u32 m0, m0, 4096
  s_nop 0
  buffer_load_dwordx4 v6, s[8:11], s41 offen lds
  s_add_u32 s41, s41, 128
  s_add_u32 m0, s28, s45
  s_add_u32 m0, m0, 8192
  s_nop 0
  buffer_load_dwordx4 v6, s[8:11], s42 offen lds
  s_add_u32 s42, s42, 128
  s_add_u32 m0, s28, s45
  s_add_u32 m0, m0, 12288
  s_nop 0
  buffer_load_dwordx4 v6, s[8:11], s43 offen lds
  s_add_u32 s43, s43, 128
  s_add_u32 m0, s28, s46
  s_nop 0
  buffer_load_dwordx4 v7, s[12:15], s44 offen lds
  s_add_u32 m0, m0, 1024
  s_nop 0
  buffer_load_dwordx4 v8, s[12:15], s44 offen lds
  s_add_u32 m0, m0, 1024
  s_nop 0
  buffer_load_dwordx4 v9, s[12:15], s44 offen lds
  s_add_u32 m0, m0, 1024
  s_nop 0
  buffer_load_dwordx4 v10, s[12:15], s44 offen lds
  s_add_u32 m0, m0, 1024
  s_mov_b32 exec_hi, 0
  buffer_load_dwordx4 v11, s[12:15], s44 offen lds
  s_mov_b64 exec, -1
  s_add_u32 s44, s44, 221184
  s_add_u32 s28, s28, 34816
  s_cmp_ge_u32 s28, 139264
  s_cselect_b32 s28, 0, s28
L_k1_lt_23:
  s_add_u32 s27, s27, 1
  s_cmp_lt_u32 s27, 8
  s_cbranch_scc1 L_k1_ll_21
  s_cmp_eq_u32 s23, 2
  s_cbranch_scc1 L_co_v_24
  s_cmp_eq_u32 s23, 0
  s_mov_b32 s38, 2432
  s_cselect_b32 s38, 1152, s38
  v_add_u32 v2, 0, v1
  v_mul_u32_u24 v3, 911, v2
  v_lshrrev_b32 v3, 16, v3
  v_mul_u32_u24 v4, 72, v3
  v_sub_u32 v4, v2, v4
  v_lshlrev_b32 v4, 4, v4
  v_mul_lo_u32 v3, v3, s38
  v_add_u32 v12, v3, v4
  v_add_u32 v2, 64, v1
  v_mul_u32_u24 v3, 911, v2
  v_lshrrev_b32 v3, 16, v3
  v_mul_u32_u24 v4, 72, v3
  v_sub_u32 v4, v2, v4
  v_lshlrev_b32 v4, 4, v4
  v_mul_lo_u32 v3, v3, s38
  v_add_u32 v13, v3, v4
  v_add_u32 v2, 128, v1
  v_mul_u32_u24 v3, 911, v2
  v_lshrrev_b32 v3, 16, v3
  v_mul_u32_u24 v4, 72, v3
  v_sub_u32 v4, v2, v4
  v_lshlrev_b32 v4, 4, v4
  v_mul_lo_u32 v3, v3, s38
  v_add_u32 v14, v3, v4
  v_add_u32 v2, 192, v1
  v_mul_u32_u24 v3, 911, v2
  v_lshrrev_b32 v3, 16, v3
  v_mul_u32_u24 v4, 72, v3
  v_sub_u32 v4, v2, v4
  v_lshlrev_b32 v4, 4, v4
  v_mul_lo_u32 v3, v3, s38
  v_add_u32 v15, v3, v4
  v_add_u32 v2, 256, v1
  v_mul_u32_u24 v3, 911, v2
  v_lshrrev_b32 v3, 16, v3
  v_mul_u32_u24 v4, 72, v3
  v_sub_u32 v4, v2, v4
  v_lshlrev_b32 v4, 4, v4
  v_mul_lo_u32 v3, v3, s38
  v_add_u32 v16, v3, v4
  s_branch L_co_e_25
L_co_v_24:
  v_add_u32 v2, 0, v1
  v_mul_u32_u24 v3, 820, v2
  v_lshrrev_b32 v3, 16, v3
  v_mul_u32_u24 v4, 80, v3
  v_sub_u32 v4, v2, v4
  v_lshlrev_b32 v4, 4, v4
  v_mul_u32_u24 v3, 2432, v3
  v_add_u32 v12, v3, v4
  v_add_u32 v12, 1152, v12
  v_add_u32 v2, 64, v1
  v_mul_u32_u24 v3, 820, v2
  v_lshrrev_b32 v3, 16, v3
  v_mul_u32_u24 v4, 80, v3
  v_sub_u32 v4, v2, v4
  v_lshlrev_b32 v4, 4, v4
  v_mul_u32_u24 v3, 2432, v3
  v_add_u32 v13, v3, v4
  v_add_u32 v13, 1152, v13
  v_add_u32 v2, 128, v1
  v_mul_u32_u24 v3, 820, v2
  v_lshrrev_b32 v3, 16, v3
  v_mul_u32_u24 v4, 80, v3
  v_sub_u32 v4, v2, v4
  v_lshlrev_b32 v4, 4, v4
  v_mul_u32_u24 v3, 2432, v3
  v_add_u32 v14, v3, v4
  v_add_u32 v14, 1152, v14
  v_add_u32 v2, 192, v1
  v_mul_u32_u24 v3, 820, v2
  v_lshrrev_b32 v3, 16, v3
  v_mul_u32_u24 v4, 80, v3
  v_sub_u32 v4, v2, v4
  v_lshlrev_b32 v4, 4, v4
  v_mul_u32_u24 v3, 2432, v3
  v_add_u32 v15, v3, v4
  v_add_u32 v15, 1152, v15
  v_add_u32 v2, 256, v1
  v_mul_u32_u24 v3, 820, v2
  v_lshrrev_b32 v3, 16, v3
  v_mul_u32_u24 v4, 80, v3
  v_sub_u32 v4, v2, v4
  v_lshlrev_b32 v4, 4, v4
  v_mul_u32_u24 v3, 2432, v3
  v_add_u32 v16, v3, v4
  v_add_u32 v16, 1152, v16
L_co_e_25:
  s_barrier
  s_cmp_eq_u32 s23, 2
  s_cbranch_scc0 L_k1_co_17
  v_lshlrev_b32 v2, 0, v1
  s_lshl_b32 s38, s24, 6
  v_add_u32 v2, s38, v2
  v_lshrrev_b32 v3, 1, v2
  v_mul_u32_u24 v3, 320, v3
  v_and_b32 v4, 1, v2
  v_lshlrev_b32 v5, 4, v4
  v_add_u32 v3, v3, v5
  v_add_u32 v3, 288, v3
  v_mov_b32 v5, 0x3f803f80
  v_cmp_eq_u32 vcc, 0, v4
  v_mov_b32 v4, 0
  s_nop 0
  v_cndmask_b32 v20, v4, v5, vcc
  v_mov_b32 v21, v20
  v_mov_b32 v22, v20
  v_mov_b32 v23, v20
  ds_write_b128 v3, v[20:23]
L_k1_co_17:
  s_mov_b32 s16, s34
  s_and_b32 s17, s35, 0xffff
  s_mov_b32 s18, 20262912
  s_mov_b32 s19, 0x20000
  s_mov_b32 s50, s20
  s_and_b32 s38, s22, 3
  s_lshl_b32 s38, s38, 3
  s_add_u32 s38, s38, s50
  s_lshl_b32 s39, s38, 6
  s_lshl_b32 s42, s21, 2
  s_add_u32 s39, s39, s42
  s_cmp_eq_u32 s23, 0
  s_mov_b32 s42, 2432
  s_cselect_b32 s42, 1152, s42
  s_mov_b32 s43, 2359296
  s_cselect_b32 s43, 0, s43
  s_mul_i32 s39, s39, s42
  s_add_u32 s39, s39, s43
  s_cmp_eq_u32 s23, 2
  s_mov_b32 s42, 4608
  s_cselect_b32 s42, 5120, s42
  s_mul_i32 s42, s42, s50
  v_lshlrev_b32 v2, 4, v1
  v_add_u32 v2, s42, v2
  s_waitcnt lgkmcnt(0)
  s_barrier
  ds_read_b128 v[20:23], v2 offset:0
  ds_read_b128 v[24:27], v2 offset:1024
  ds_read_b128 v[28:31], v2 offset:2048
  ds_read_b128 v[32:35], v2 offset:3072
  ds_read_b128 v[36:39], v2 offset:4096
  s_waitcnt lgkmcnt(4)
  buffer_store_dwordx4 v[20:23], v12, s[16:19], s39 offen
  s_waitcnt lgkmcnt(3)
  buffer_store_dwordx4 v[24:27], v13, s[16:19], s39 offen
  s_waitcnt lgkmcnt(2)
  buffer_store_dwordx4 v[28:31], v14, s[16:19], s39 offen
  s_waitcnt lgkmcnt(1)
  buffer_store_dwordx4 v[32:35], v15, s[16:19], s39 offen
  s_waitcnt lgkmcnt(0)
  s_cmp_eq_u32 s23, 2
  s_cbranch_scc1 L_full5_26
  s_mov_b32 exec_hi, 0
L_full5_26:
  buffer_store_dwordx4 v[36:39], v16, s[16:19], s39 offen
  s_mov_b64 exec, -1
  s_cmp_eq_u32 s23, 1
  s_cbranch_scc0 L_k1_nok_19
  v_lshrrev_b32 v2, 5, v1
  v_add_u32 v2, 0, v2
  v_mul_u32_u24 v2, 1152, v2
  v_add_u32 v2, s42, v2
  v_and_b32 v3, 31, v1
  v_lshlrev_b32 v4, 4, v3
  v_add_u32 v4, v2, v4
  v_lshlrev_b32 v3, 2, v3
  v_add_u32 v3, v2, v3
  ds_read_b128 v[40:43], v4
  ds_read_b128 v[44:47], v4 offset:512
  ds_read_b32 v48, v3 offset:1024
  s_waitcnt lgkmcnt(0)
  v_mov_b32 v50, 0
  v_dot2_f32_bf16 v50, v40, v40, v50
  v_dot2_f32_bf16 v50, v41, v41, v50
  v_dot2_f32_bf16 v50, v42, v42, v50
  v_dot2_f32_bf16 v50, v43, v43, v50
  v_dot2_f32_bf16 v50, v44, v44, v50
  v_dot2_f32_bf16 v50, v45, v45, v50
  v_dot2_f32_bf16 v50, v46, v46, v50
  v_dot2_f32_bf16 v50, v47, v47, v50
  v_dot2_f32_bf16 v50, v48, v48, v50
  s_nop 2
  v_lshrrev_b32 v2, 5, v1
  v_add_u32 v2, 2, v2
  v_mul_u32_u24 v2, 1152, v2
  v_add_u32 v2, s42, v2
  v_and_b32 v3, 31, v1
  v_lshlrev_b32 v4, 4, v3
  v_add_u32 v4, v2, v4
  v_lshlrev_b32 v3, 2, v3
  v_add_u32 v3, v2, v3
  ds_read_b128 v[40:43], v4
  ds_read_b128 v[44:47], v4 offset:512
  ds_read_b32 v48, v3 offset:1024
  s_waitcnt lgkmcnt(0)
  v_mov_b32 v51, 0
  v_dot2_f32_bf16 v51, v40, v40, v51
  v_dot2_f32_bf16 v51, v41, v41, v51
  v_dot2_f32_bf16 v51, v42, v42, v51
  v_dot2_f32_bf16 v51, v43, v43, v51
  v_dot2_f32_bf16 v51, v44, v44, v51
  v_dot2_f32_bf16 v51, v45, v45, v51
  v_dot2_f32_bf16 v51, v46, v46, v51
  v_dot2_f32_bf16 v51, v47, v47, v51
  v_dot2_f32_bf16 v51, v48, v48, v51
  s_nop 2
  v_max_f32 v50, v50, v51
  s_nop 1
  v_max_f32_dpp v50, v50, v50 row_shr:1
  s_nop 1
  v_max_f32_dpp v50, v50, v50 row_shr:2
  s_nop 1
  v_max_f32_dpp v50, v50, v50 row_shr:4
  s_nop 1
  v_max_f32_dpp v50, v50, v50 row_shr:8
  s_nop 1
  v_max_f32_dpp v50, v50, v50 row_bcast:15 row_mask:0xa
  s_nop 1
  v_max_f32_dpp v50, v50, v50 row_bcast:31 row_mask:0xc
  s_nop 1
  v_readlane_b32 s43, v50, 63
  s_lshl_b32 s38, s38, 6
  s_lshl_b32 s44, s21, 2
  s_add_u32 s38, s38, s44
  s_add_u32 s38, s38, 7340032
  v_mov_b32 v2, s43
  v_mov_b32 v3, 0
  s_mov_b64 exec, 1
  buffer_store_dword v2, v3, s[16:19], s38 offen
  s_mov_b64 exec, -1
L_k1_nok_19:
  s_endpgm
L_k1_prep:
  s_sub_u32 s3, s2, 192
  s_load_dwordx4 s[4:7], s[0:1], 8
  s_load_dwordx4 s[8:11], s[0:1], 40
  s_load_dwordx2 s[12:13], s[0:1], 56
  s_load_dwordx2 s[14:15], s[0:1], 88
  s_load_dwordx2 s[16:17], s[0:1], 112
  s_load_dwordx2 s[56:57], s[0:1], 0
  s_load_dwordx4 s[60:63], s[0:1], 24
  v_mov_b32 v1, v0
  s_waitcnt lgkmcnt(0)
  s_mov_b32 s20, s4
  s_and_b32 s21, s5, 0xffff
  s_mov_b32 s22, 1152
  s_mov_b32 s23, 0x20000
  s_mov_b32 s24, s6
  s_and_b32 s25, s7, 0xffff
  s_mov_b32 s26, 1152
  s_mov_b32 s27, 0x20000
  s_mov_b32 s28, s12
  s_and_b32 s29, s13, 0xffff
  s_mov_b32 s30, 1152
  s_mov_b32 s31, 0x20000
  s_mov_b32 s32, s8
  s_and_b32 s33, s9, 0xffff
  s_mov_b32 s34, 663552
  s_mov_b32 s35, 0x20000
  s_mov_b32 s36, s10
  s_and_b32 s37, s11, 0xffff
  s_mov_b32 s38, 663552
  s_mov_b32 s39, 0x20000
  s_mov_b32 s40, s14
  s_and_b32 s41, s15, 0xffff
  s_mov_b32 s42, 663552
  s_mov_b32 s43, 0x20000
  s_mov_b32 s44, s16
  s_and_b32 s45, s17, 0xffff
  s_mov_b32 s46, 20262912
  s_mov_b32 s47, 0x20000
  s_cmp_eq_u32 s3, 0
  s_cbranch_scc0 L_prep_z_27
  v_cmp_gt_u32 vcc, 64, v1
  s_and_saveexec_b64 s[52:53], vcc
  s_cbranch_execz L_prep_z_27
  v_lshlrev_b32 v16, 8, v1
  v_mov_b32 v17, 0
  s_mov_b32 s83, 20246528
  buffer_store_dword v17, v16, s[44:47], s83 offen
L_prep_z_27:
  s_mov_b64 exec, -1
  v_cmp_gt_u32 vcc, 144, v1
  s_and_saveexec_b64 s[52:53], vcc
  s_cbranch_execz L_prep_e_28
  v_lshlrev_b32 v16, 4, v1
  v_mov_b32 v12, -1
  v_mov_b32 v13, -1
  v_mov_b32 v14, -1
  v_mov_b32 v15, -1
  s_mul_i32 s83, s3, 2304
  s_add_u32 s83, s83, 20099072
  buffer_store_dwordx4 v[12:15], v16, s[44:47], s83 offen
L_prep_e_28:
  s_mov_b64 exec, -1
  v_lshlrev_b32 v16, 4, v1
  v_mov_b32 v12, -1
  v_mov_b32 v13, -1
  v_mov_b32 v14, -1
  v_mov_b32 v15, -1
  s_mul_i32 s83, s3, 36864
  s_add_u32 s83, s83, 7344128
  buffer_store_dwordx4 v[12:15], v16, s[44:47], s83 offen
  s_add_u32 s83, s83, 8192
  buffer_store_dwordx4 v[12:15], v16, s[44:47], s83 offen
  s_add_u32 s83, s83, 8192
  buffer_store_dwordx4 v[12:15], v16, s[44:47], s83 offen
  s_add_u32 s83, s83, 8192
  buffer_store_dwordx4 v[12:15], v16, s[44:47], s83 offen
  s_add_u32 s83, s83, 8192
  v_cmp_gt_u32 vcc, 256, v1
  s_and_saveexec_b64 s[52:53], vcc
  s_cbranch_execz L_prep_e_28_o
  buffer_store_dwordx4 v[12:15], v16, s[44:47], s83 offen
L_prep_e_28_o:
  s_mov_b64 exec, -1
  s_mov_b32 s64, s56
  s_and_b32 s65, s57, 0xffff
  s_mov_b32 s66, 2359296
  s_mov_b32 s67, 0x20000
  v_readfirstlane_b32 s76, v1
  s_cmp_lt_u32 s76, 256
  s_cselect_b32 s68, s60, s62
  s_cselect_b32 s69, s61, s63
  s_and_b32 s69, s69, 0xffff
  s_mov_b32 s70, 663552
  s_mov_b32 s71, 0x20000
  v_lshrrev_b32 v4, 2, v1
  v_lshrrev_b32 v5, 2, v4
  v_xor_b32 v5, v5, v1
  v_and_b32 v5, 3, v5
  v_lshlrev_b32 v5, 4, v5
  v_and_b32 v6, 63, v4
  v_mul_u32_u24 v6, 1152, v6
  v_add_u32 v53, v6, v5
  v_and_b32 v6, 32, v4
  v_lshrrev_b32 v7, 2, v4
  v_and_b32 v7, 1, v7
  v_lshlrev_b32 v7, 4, v7
  v_add_u32 v6, v6, v7
  v_lshrrev_b32 v7, 3, v4
  v_and_b32 v7, 3, v7
  v_lshlrev_b32 v7, 2, v7
  v_add_u32 v6, v6, v7
  v_and_b32 v7, 3, v4
  v_add_u32 v6, v6, v7
  v_mul_u32_u24 v6, 1152, v6
  v_add_u32 v52, v6, v5
  v_and_b32 v55, 255, v1
  v_lshlrev_b32 v55, 4, v55
  s_lshr_b32 s82, s76, 8
  v_lshlrev_b32 v54, 4, v1
  s_and_b32 s77, s3, 7
  s_lshr_b32 s78, s3, 3
  s_lshr_b32 s48, s3, 3
  s_and_b32 s49, s3, 7
  s_mul_i32 s50, s48, 82944
  s_mul_i32 s51, s49, 144
  s_add_u32 s50, s50, s51
  v_add_u32 v4, 0, v1
  v_mul_u32_u24 v5, 7282, v4
  v_lshrrev_b32 v5, 16, v5
  v_mul_u32_u24 v6, 9, v5
  v_sub_u32 v6, v4, v6
  v_mul_u32_u24 v7, 1152, v5
  v_lshlrev_b32 v8, 4, v6
  v_add_u32 v7, v7, v8
  v_mul_u32_u24 v64, 160, v5
  v_add_u32 v64, v64, v8
  buffer_load_dwordx4 v[56:59], v7, s[40:43], s50 offen
  v_add_u32 v4, 512, v1
  v_mul_u32_u24 v5, 7282, v4
  v_lshrrev_b32 v5, 16, v5
  v_mul_u32_u24 v6, 9, v5
  v_sub_u32 v6, v4, v6
  v_mul_u32_u24 v7, 1152, v5
  v_lshlrev_b32 v8, 4, v6
  v_add_u32 v7, v7, v8
  v_mul_u32_u24 v65, 160, v5
  v_add_u32 v65, v65, v8
  buffer_load_dwordx4 v[60:63], v7, s[40:43], s50 offen
  v_lshlrev_b32 v4, 2, v1
  buffer_load_dword v5, v4, s[20:23], 0 offen
  buffer_load_dword v6, v4, s[24:27], 0 offen
  buffer_load_dword v7, v4, s[28:31], 0 offen
  v_min_u32 v11, 1148, v4
  s_mul_i32 s54, s3, 10368
  buffer_load_dword v80, v11, s[32:35], s54 offen
  buffer_load_dword v92, v11, s[36:39], s54 offen
  s_add_u32 s54, s54, 1152
  buffer_load_dword v81, v11, s[32:35], s54 offen
  buffer_load_dword v93, v11, s[36:39], s54 offen
  s_add_u32 s54, s54, 1152
  buffer_load_dword v82, v11, s[32:35], s54 offen
  buffer_load_dword v94, v11, s[36:39], s54 offen
  s_add_u32 s54, s54, 1152
  buffer_load_dword v83, v11, s[32:35], s54 offen
  buffer_load_dword v95, v11, s[36:39], s54 offen
  s_add_u32 s54, s54, 1152
  buffer_load_dword v84, v11, s[32:35], s54 offen
  buffer_load_dword v96, v11, s[36:39], s54 offen
  s_add_u32 s54, s54, 1152
  buffer_load_dword v85, v11, s[32:35], s54 offen
  buffer_load_dword v97, v11, s[36:39], s54 offen
  s_add_u32 s54, s54, 1152
  buffer_load_dword v86, v11, s[32:35], s54 offen
  buffer_load_dword v98, v11, s[36:39], s54 offen
  s_add_u32 s54, s54, 1152
  buffer_load_dword v87, v11, s[32:35], s54 offen
  buffer_load_dword v99, v11, s[36:39], s54 offen
  s_add_u32 s54, s54, 1152
  buffer_load_dword v88, v11, s[32:35], s54 offen
  buffer_load_dword v100, v11, s[36:39], s54 offen
  s_add_u32 s54, s54, 1152
  s_waitcnt vmcnt(21)
  ds_write_b128 v64, v[56:59]
  v_cmp_gt_u32 vcc, 136, v1
  s_and_saveexec_b64 s[52:53], vcc
  s_cbranch_execz L_prep_skipc_29_w
  ds_write_b128 v65, v[60:63]
L_prep_skipc_29_w:
  s_mov_b64 exec, -1
  v_cmp_gt_u32 vcc, 288, v1
  s_and_saveexec_b64 s[52:53], vcc
  s_cbranch_execz L_prep_skipc_29
  s_waitcnt vmcnt(0)
  v_lshlrev_b32 v66, 16, v5
  v_and_b32 v67, 0xffff0000, v5
  v_lshlrev_b32 v68, 16, v6
  v_and_b32 v69, 0xffff0000, v6
  v_lshlrev_b32 v70, 16, v7
  v_and_b32 v71, 0xffff0000, v7
  v_mul_f32 v70, 0x3fb8aa3b, v70
  v_exp_f32 v70, v70
  s_nop 0
  v_cvt_pk_bf16_f32 v70, v70, v70
  v_and_b32 v70, 0xffff0000, v70
  v_mul_f32 v8, v70, v66
  v_mul_f32 v9, v70, v68
  v_mul_f32 v8, 0x3fb8aa3b, v8
  v_exp_f32 v8, v8
  v_mul_f32 v9, 0.15915494, v9
  v_fract_f32 v9, v9
  v_cos_f32 v10, v9
  v_sin_f32 v9, v9
  s_nop 0
  v_mul_f32 v76, v8, v10
  v_mul_f32 v77, v8, v9
  v_add_f32 v8, -1.0, v76
  v_mul_f32 v9, v66, v66
  v_fma_f32 v9, v68, v68, v9
  v_rcp_f32 v9, v9
  v_mul_f32 v72, v8, v66
  v_fma_f32 v72, v77, v68, v72
  v_mul_f32 v74, v77, v66
  v_fma_f32 v74, -v8, v68, v74
  v_mul_f32 v72, v72, v9
  v_mul_f32 v74, v74, v9
  v_mul_f32 v71, 0x3fb8aa3b, v71
  v_exp_f32 v71, v71
  s_nop 0
  v_cvt_pk_bf16_f32 v71, v71, v71
  v_and_b32 v71, 0xffff0000, v71
  v_mul_f32 v8, v71, v67
  v_mul_f32 v9, v71, v69
  v_mul_f32 v8, 0x3fb8aa3b, v8
  v_exp_f32 v8, v8
  v_mul_f32 v9, 0.15915494, v9
  v_fract_f32 v9, v9
  v_cos_f32 v10, v9
  v_sin_f32 v9, v9
  s_nop 0
  v_mul_f32 v76, v8, v10
  v_mul_f32 v77, v8, v9
  v_add_f32 v8, -1.0, v76
  v_mul_f32 v9, v67, v67
  v_fma_f32 v9, v69, v69, v9
  v_rcp_f32 v9, v9
  v_mul_f32 v73, v8, v67
  v_fma_f32 v73, v77, v69, v73
  v_mul_f32 v75, v77, v67
  v_fma_f32 v75, -v8, v69, v75
  v_mul_f32 v73, v73, v9
  v_mul_f32 v75, v75, v9
  v_lshrrev_b32 v104, 3, v1
  v_lshlrev_b32 v104, 12, v104
  v_and_b32 v4, 1, v1
  v_lshlrev_b32 v4, 3, v4
  v_add_u32 v104, v104, v4
  v_lshrrev_b32 v105, 1, v1
  v_and_b32 v105, 3, v105
  s_mul_i32 s55, s3, 9
  v_lshlrev_b32 v5, 16, v80
  v_lshlrev_b32 v6, 16, v92
  v_mul_f32 v7, v5, v72
  v_fma_f32 v7, -v6, v74, v7
  v_mul_f32 v8, v5, v74
  v_fma_f32 v8, v6, v72, v8
  v_mul_f32 v7, 2.0, v7
  v_mul_f32 v8, -2.0, v8
  v_cvt_pk_bf16_f32 v102, v7, v8
  v_and_b32 v5, 0xffff0000, v80
  v_and_b32 v6, 0xffff0000, v92
  v_mul_f32 v7, v5, v73
  v_fma_f32 v7, -v6, v75, v7
  v_mul_f32 v8, v5, v75
  v_fma_f32 v8, v6, v73, v8
  v_mul_f32 v7, 2.0, v7
  v_mul_f32 v8, -2.0, v8
  v_cvt_pk_bf16_f32 v103, v7, v8
  s_lshr_b32 s54, s55, 6
  s_mul_i32 s54, s54, 147456
  s_and_b32 s58, s55, 63
  s_lshl_b32 s59, s58, 6
  s_add_u32 s54, s54, s59
  s_add_u32 s54, s54, 10366976
  s_lshr_b32 s58, s58, 2
  s_and_b32 s58, s58, 3
  v_xor_b32 v4, s58, v105
  v_lshlrev_b32 v4, 4, v4
  v_add_u32 v4, v4, v104
  buffer_store_dwordx2 v[102:103], v4, s[44:47], s54 offen
  s_add_u32 s55, s55, 1
  s_nop 0
  v_lshlrev_b32 v5, 16, v81
  v_lshlrev_b32 v6, 16, v93
  v_mul_f32 v7, v5, v72
  v_fma_f32 v7, -v6, v74, v7
  v_mul_f32 v8, v5, v74
  v_fma_f32 v8, v6, v72, v8
  v_mul_f32 v7, 2.0, v7
  v_mul_f32 v8, -2.0, v8
  v_cvt_pk_bf16_f32 v102, v7, v8
  v_and_b32 v5, 0xffff0000, v81
  v_and_b32 v6, 0xffff0000, v93
  v_mul_f32 v7, v5, v73
  v_fma_f32 v7, -v6, v75, v7
  v_mul_f32 v8, v5, v75
  v_fma_f32 v8, v6, v73, v8
  v_mul_f32 v7, 2.0, v7
  v_mul_f32 v8, -2.0, v8
  v_cvt_pk_bf16_f32 v103, v7, v8
  s_lshr_b32 s54, s55, 6
  s_mul_i32 s54, s54, 147456
  s_and_b32 s58, s55, 63
  s_lshl_b32 s59, s58, 6
  s_add_u32 s54, s54, s59
  s_add_u32 s54, s54, 10366976
  s_lshr_b32 s58, s58, 2
  s_and_b32 s58, s58, 3
  v_xor_b32 v4, s58, v105
  v_lshlrev_b32 v4, 4, v4
  v_add_u32 v4, v4, v104
  buffer_store_dwordx2 v[102:103], v4, s[44:47], s54 offen
  s_add_u32 s55, s55, 1
  s_nop 0
  v_lshlrev_b32 v5, 16, v82
  v_lshlrev_b32 v6, 16, v94
  v_mul_f32 v7, v5, v72
  v_fma_f32 v7, -v6, v74, v7
  v_mul_f32 v8, v5, v74
  v_fma_f32 v8, v6, v72, v8
  v_mul_f32 v7, 2.0, v7
  v_mul_f32 v8, -2.0, v8
  v_cvt_pk_bf16_f32 v102, v7, v8
  v_and_b32 v5, 0xffff0000, v82
  v_and_b32 v6, 0xffff0000, v94
  v_mul_f32 v7, v5, v73
  v_fma_f32 v7, -v6, v75, v7
  v_mul_f32 v8, v5, v75
  v_fma_f32 v8, v6, v73, v8
  v_mul_f32 v7, 2.0, v7
  v_mul_f32 v8, -2.0, v8
  v_cvt_pk_bf16_f32 v103, v7, v8
  s_lshr_b32 s54, s55, 6
  s_mul_i32 s54, s54, 147456
  s_and_b32 s58, s55, 63
  s_lshl_b32 s59, s58, 6
  s_add_u32 s54, s54, s59
  s_add_u32 s54, s54, 10366976
  s_lshr_b32 s58, s58, 2
  s_and_b32 s58, s58, 3
  v_xor_b32 v4, s58, v105
  v_lshlrev_b32 v4, 4, v4
  v_add_u32 v4, v4, v104
  buffer_store_dwordx2 v[102:103], v4, s[44:47], s54 offen
  s_add_u32 s55, s55, 1
  s_nop 0
  v_lshlrev_b32 v5, 16, v83
  v_lshlrev_b32 v6, 16, v95
  v_mul_f32 v7, v5, v72
  v_fma_f32 v7, -v6, v74, v7
  v_mul_f32 v8, v5, v74
  v_fma_f32 v8, v6, v72, v8
  v_mul_f32 v7, 2.0, v7
  v_mul_f32 v8, -2.0, v8
  v_cvt_pk_bf16_f32 v102, v7, v8
  v_and_b32 v5, 0xffff0000, v83
  v_and_b32 v6, 0xffff0000, v95
  v_mul_f32 v7, v5, v73
  v_fma_f32 v7, -v6, v75, v7
  v_mul_f32 v8, v5, v75
  v_fma_f32 v8, v6, v73, v8
  v_mul_f32 v7, 2.0, v7
  v_mul_f32 v8, -2.0, v8
  v_cvt_pk_bf16_f32 v103, v7, v8
  s_lshr_b32 s54, s55, 6
  s_mul_i32 s54, s54, 147456
  s_and_b32 s58, s55, 63
  s_lshl_b32 s59, s58, 6
  s_add_u32 s54, s54, s59
  s_add_u32 s54, s54, 10366976
  s_lshr_b32 s58, s58, 2
  s_and_b32 s58, s58, 3
  v_xor_b32 v4, s58, v105
  v_lshlrev_b32 v4, 4, v4
  v_add_u32 v4, v4, v104
  buffer_store_dwordx2 v[102:103], v4, s[44:47], s54 offen
  s_add_u32 s55, s55, 1
  s_nop 0
  v_lshlrev_b32 v5, 16, v84
  v_lshlrev_b32 v6, 16, v96
  v_mul_f32 v7, v5, v72
  v_fma_f32 v7, -v6, v74, v7
  v_mul_f32 v8, v5, v74
  v_fma_f32 v8, v6, v72, v8
  v_mul_f32 v7, 2.0, v7
  v_mul_f32 v8, -2.0, v8
  v_cvt_pk_bf16_f32 v102, v7, v8
  v_and_b32 v5, 0xffff0000, v84
  v_and_b32 v6, 0xffff0000, v96
  v_mul_f32 v7, v5, v73
  v_fma_f32 v7, -v6, v75, v7
  v_mul_f32 v8, v5, v75
  v_fma_f32 v8, v6, v73, v8
  v_mul_f32 v7, 2.0, v7
  v_mul_f32 v8, -2.0, v8
  v_cvt_pk_bf16_f32 v103, v7, v8
  s_lshr_b32 s54, s55, 6
  s_mul_i32 s54, s54, 147456
  s_and_b32 s58, s55, 63
  s_lshl_b32 s59, s58, 6
  s_add_u32 s54, s54, s59
  s_add_u32 s54, s54, 10366976
  s_lshr_b32 s58, s58, 2
  s_and_b32 s58, s58, 3
  v_xor_b32 v4, s58, v105
  v_lshlrev_b32 v4, 4, v4
  v_add_u32 v4, v4, v104
  buffer_store_dwordx2 v[102:103], v4, s[44:47], s54 offen
  s_add_u32 s55, s55, 1
  s_nop 0
  v_lshlrev_b32 v5, 16, v85
  v_lshlrev_b32 v6, 16, v97
  v_mul_f32 v7, v5, v72
  v_fma_f32 v7, -v6, v74, v7
  v_mul_f32 v8, v5, v74
  v_fma_f32 v8, v6, v72, v8
  v_mul_f32 v7, 2.0, v7
  v_mul_f32 v8, -2.0, v8
  v_cvt_pk_bf16_f32 v102, v7, v8
  v_and_b32 v5, 0xffff0000, v85
  v_and_b32 v6, 0xffff0000, v97
  v_mul_f32 v7, v5, v73
  v_fma_f32 v7, -v6, v75, v7
  v_mul_f32 v8, v5, v75
  v_fma_f32 v8, v6, v73, v8
  v_mul_f32 v7, 2.0, v7
  v_mul_f32 v8, -2.0, v8
  v_cvt_pk_bf16_f32 v103, v7, v8
  s_lshr_b32 s54, s55, 6
  s_mul_i32 s54, s54, 147456
  s_and_b32 s58, s55, 63
  s_lshl_b32 s59, s58, 6
  s_add_u32 s54, s54, s59
  s_add_u32 s54, s54, 10366976
  s_lshr_b32 s58, s58, 2
  s_and_b32 s58, s58, 3
  v_xor_b32 v4, s58, v105
  v_lshlrev_b32 v4, 4, v4
  v_add_u32 v4, v4, v104
  buffer_store_dwordx2 v[102:103], v4, s[44:47], s54 offen
  s_add_u32 s55, s55, 1
  s_nop 0
  v_lshlrev_b32 v5, 16, v86
  v_lshlrev_b32 v6, 16, v98
  v_mul_f32 v7, v5, v72
  v_fma_f32 v7, -v6, v74, v7
  v_mul_f32 v8, v5, v74
  v_fma_f32 v8, v6, v72, v8
  v_mul_f32 v7, 2.0, v7
  v_mul_f32 v8, -2.0, v8
  v_cvt_pk_bf16_f32 v102, v7, v8
  v_and_b32 v5, 0xffff0000, v86
  v_and_b32 v6, 0xffff0000, v98
  v_mul_f32 v7, v5, v73
  v_fma_f32 v7, -v6, v75, v7
  v_mul_f32 v8, v5, v75
  v_fma_f32 v8, v6, v73, v8
  v_mul_f32 v7, 2.0, v7
  v_mul_f32 v8, -2.0, v8
  v_cvt_pk_bf16_f32 v103, v7, v8
  s_lshr_b32 s54, s55, 6
  s_mul_i32 s54, s54, 147456
  s_and_b32 s58, s55, 63
  s_lshl_b32 s59, s58, 6
  s_add_u32 s54, s54, s59
  s_add_u32 s54, s54, 10366976
  s_lshr_b32 s58, s58, 2
  s_and_b32 s58, s58, 3
  v_xor_b32 v4, s58, v105
  v_lshlrev_b32 v4, 4, v4
  v_add_u32 v4, v4, v104
  buffer_store_dwordx2 v[102:103], v4, s[44:47], s54 offen
  s_add_u32 s55, s55, 1
  s_nop 0
  v_lshlrev_b32 v5, 16, v87
  v_lshlrev_b32 v6, 16, v99
  v_mul_f32 v7, v5, v72
  v_fma_f32 v7, -v6, v74, v7
  v_mul_f32 v8, v5, v74
  v_fma_f32 v8, v6, v72, v8
  v_mul_f32 v7, 2.0, v7
  v_mul_f32 v8, -2.0, v8
  v_cvt_pk_bf16_f32 v102, v7, v8
  v_and_b32 v5, 0xffff0000, v87
  v_and_b32 v6, 0xffff0000, v99
  v_mul_f32 v7, v5, v73
  v_fma_f32 v7, -v6, v75, v7
  v_mul_f32 v8, v5, v75
  v_fma_f32 v8, v6, v73, v8
  v_mul_f32 v7, 2.0, v7
  v_mul_f32 v8, -2.0, v8
  v_cvt_pk_bf16_f32 v103, v7, v8
  s_lshr_b32 s54, s55, 6
  s_mul_i32 s54, s54, 147456
  s_and_b32 s58, s55, 63
  s_lshl_b32 s59, s58, 6
  s_add_u32 s54, s54, s59
  s_add_u32 s54, s54, 10366976
  s_lshr_b32 s58, s58, 2
  s_and_b32 s58, s58, 3
  v_xor_b32 v4, s58, v105
  v_lshlrev_b32 v4, 4, v4
  v_add_u32 v4, v4, v104
  buffer_store_dwordx2 v[102:103], v4, s[44:47], s54 offen
  s_add_u32 s55, s55, 1
  s_nop 0
  v_lshlrev_b32 v5, 16, v88
  v_lshlrev_b32 v6, 16, v100
  v_mul_f32 v7, v5, v72
  v_fma_f32 v7, -v6, v74, v7
  v_mul_f32 v8, v5, v74
  v_fma_f32 v8, v6, v72, v8
  v_mul_f32 v7, 2.0, v7
  v_mul_f32 v8, -2.0, v8
  v_cvt_pk_bf16_f32 v102, v7, v8
  v_and_b32 v5, 0xffff0000, v88
  v_and_b32 v6, 0xffff0000, v100
  v_mul_f32 v7, v5, v73
  v_fma_f32 v7, -v6, v75, v7
  v_mul_f32 v8, v5, v75
  v_fma_f32 v8, v6, v73, v8
  v_mul_f32 v7, 2.0, v7
  v_mul_f32 v8, -2.0, v8
  v_cvt_pk_bf16_f32 v103, v7, v8
  s_lshr_b32 s54, s55, 6
  s_mul_i32 s54, s54, 147456
  s_and_b32 s58, s55, 63
  s_lshl_b32 s59, s58, 6
  s_add_u32 s54, s54, s59
  s_add_u32 s54, s54, 10366976
  s_lshr_b32 s58, s58, 2
  s_and_b32 s58, s58, 3
  v_xor_b32 v4, s58, v105
  v_lshlrev_b32 v4, 4, v4
  v_add_u32 v4, v4, v104
  buffer_store_dwordx2 v[102:103], v4, s[44:47], s54 offen
  s_add_u32 s55, s55, 1
  s_nop 0
L_prep_skipc_29:
  s_mov_b64 exec, -1
  s_waitcnt lgkmcnt(0)
  s_barrier
  v_add_u32 v4, 0, v1
  v_cmp_gt_u32 vcc, 648, v4
  s_and_saveexec_b64 s[52:53], vcc
  s_cbranch_execz L_prep_o_30
  v_mul_u32_u24 v5, 7282, v4
  v_lshrrev_b32 v5, 16, v5
  v_mul_u32_u24 v6, 9, v5
  v_sub_u32 v6, v4, v6
  v_lshrrev_b32 v7, 1, v6
  v_mul_u32_u24 v7, 18, v7
  v_and_b32 v8, 1, v6
  v_lshlrev_b32 v8, 2, v8
  v_add_u32 v7, v7, v8
  v_mul_u32_u24 v7, 160, v7
  v_lshlrev_b32 v8, 1, v5
  v_add_u32 v7, v7, v8
  v_cmp_eq_u32 vcc, 8, v6
  v_add_u32 v9, 0, v7
  v_add_u32 v10, 2560, v8
  v_cndmask_b32 v9, v9, v10, vcc
  ds_read_u16 v108, v9
  v_add_u32 v9, 160, v7
  v_add_u32 v10, 2720, v8
  v_cndmask_b32 v9, v9, v10, vcc
  ds_read_u16 v109, v9
  v_add_u32 v9, 320, v7
  v_add_u32 v10, 5440, v8
  v_cndmask_b32 v9, v9, v10, vcc
  ds_read_u16 v110, v9
  v_add_u32 v9, 480, v7
  v_add_u32 v10, 5600, v8
  v_cndmask_b32 v9, v9, v10, vcc
  ds_read_u16 v111, v9
  v_add_u32 v9, 1280, v7
  v_add_u32 v10, 8320, v8
  v_cndmask_b32 v9, v9, v10, vcc
  ds_read_u16 v112, v9
  v_add_u32 v9, 1440, v7
  v_add_u32 v10, 8480, v8
  v_cndmask_b32 v9, v9, v10, vcc
  ds_read_u16 v113, v9
  v_add_u32 v9, 1600, v7
  v_add_u32 v10, 11200, v8
  v_cndmask_b32 v9, v9, v10, vcc
  ds_read_u16 v114, v9
  v_add_u32 v9, 1760, v7
  v_add_u32 v10, 11360, v8
  v_cndmask_b32 v9, v9, v10, vcc
  ds_read_u16 v115, v9
  s_waitcnt lgkmcnt(0)
  v_lshlrev_b32 v109, 16, v109
  v_or_b32 v116, v108, v109
  v_lshlrev_b32 v111, 16, v111
  v_or_b32 v117, v110, v111
  v_lshlrev_b32 v113, 16, v113
  v_or_b32 v118, v112, v113
  v_lshlrev_b32 v115, 16, v115
  v_or_b32 v119, v114, v115
  s_mul_i32 s54, s49, 72
  v_add_u32 v5, s54, v5
  v_lshrrev_b32 v9, 2, v6
  s_lshl_b32 s54, s48, 1
  v_add_u32 v9, s54, v9
  s_lshr_b32 s54, s48, 2
  s_add_u32 s54, s54, 16
  v_mov_b32 v10, s54
  v_cndmask_b32 v9, v9, v10, vcc
  v_and_b32 v7, 3, v6
  s_and_b32 s54, s48, 3
  v_mov_b32 v10, s54
  v_cndmask_b32 v7, v7, v10, vcc
  v_lshrrev_b32 v10, 6, v5
  v_mul_u32_u24 v10, 18, v10
  v_add_u32 v9, v9, v10
  v_lshlrev_b32 v9, 12, v9
  v_and_b32 v5, 63, v5
  v_lshrrev_b32 v10, 2, v5
  v_and_b32 v10, 3, v10
  v_xor_b32 v7, v7, v10
  v_lshlrev_b32 v7, 4, v7
  v_lshlrev_b32 v5, 6, v5
  v_add3_u32 v5, v5, v7, v9
  s_mov_b32 s54, 9703424
  buffer_store_dwordx4 v[116:119], v5, s[44:47], s54 offen
L_prep_o_30:
  s_mov_b64 exec, -1
  v_add_u32 v4, 512, v1
  v_cmp_gt_u32 vcc, 648, v4
  s_and_saveexec_b64 s[52:53], vcc
  s_cbranch_execz L_prep_o_31
  v_mul_u32_u24 v5, 7282, v4
  v_lshrrev_b32 v5, 16, v5
  v_mul_u32_u24 v6, 9, v5
  v_sub_u32 v6, v4, v6
  v_lshrrev_b32 v7, 1, v6
  v_mul_u32_u24 v7, 18, v7
  v_and_b32 v8, 1, v6
  v_lshlrev_b32 v8, 2, v8
  v_add_u32 v7, v7, v8
  v_mul_u32_u24 v7, 160, v7
  v_lshlrev_b32 v8, 1, v5
  v_add_u32 v7, v7, v8
  v_cmp_eq_u32 vcc, 8, v6
  v_add_u32 v9, 0, v7
  v_add_u32 v10, 2560, v8
  v_cndmask_b32 v9, v9, v10, vcc
  ds_read_u16 v108, v9
  v_add_u32 v9, 160, v7
  v_add_u32 v10, 2720, v8
  v_cndmask_b32 v9, v9, v10, vcc
  ds_read_u16 v109, v9
  v_add_u32 v9, 320, v7
  v_add_u32 v10, 5440, v8
  v_cndmask_b32 v9, v9, v10, vcc
  ds_read_u16 v110, v9
  v_add_u32 v9, 480, v7
  v_add_u32 v10, 5600, v8
  v_cndmask_b32 v9, v9, v10, vcc
  ds_read_u16 v111, v9
  v_add_u32 v9, 1280, v7
  v_add_u32 v10, 8320, v8
  v_cndmask_b32 v9, v9, v10, vcc
  ds_read_u16 v112, v9
  v_add_u32 v9, 1440, v7
  v_add_u32 v10, 8480, v8
  v_cndmask_b32 v9, v9, v10, vcc
  ds_read_u16 v113, v9
  v_add_u32 v9, 1600, v7
  v_add_u32 v10, 11200, v8
  v_cndmask_b32 v9, v9, v10, vcc
  ds_read_u16 v114, v9
  v_add_u32 v9, 1760, v7
  v_add_u32 v10, 11360, v8
  v_cndmask_b32 v9, v9, v10, vcc
  ds_read_u16 v115, v9
  s_waitcnt lgkmcnt(0)
  v_lshlrev_b32 v109, 16, v109
  v_or_b32 v116, v108, v109
  v_lshlrev_b32 v111, 16, v111
  v_or_b32 v117, v110, v111
  v_lshlrev_b32 v113, 16, v113
  v_or_b32 v118, v112, v113
  v_lshlrev_b32 v115, 16, v115
  v_or_b32 v119, v114, v115
  s_mul_i32 s54, s49, 72
  v_add_u32 v5, s54, v5
  v_lshrrev_b32 v9, 2, v6
  s_lshl_b32 s54, s48, 1
  v_add_u32 v9, s54, v9
  s_lshr_b32 s54, s48, 2
  s_add_u32 s54, s54, 16
  v_mov_b32 v10, s54
  v_cndmask_b32 v9, v9, v10, vcc
  v_and_b32 v7, 3, v6
  s_and_b32 s54, s48, 3
  v_mov_b32 v10, s54
  v_cndmask_b32 v7, v7, v10, vcc
  v_lshrrev_b32 v10, 6, v5
  v_mul_u32_u24 v10, 18, v10
  v_add_u32 v9, v9, v10
  v_lshlrev_b32 v9, 12, v9
  v_and_b32 v5, 63, v5
  v_lshrrev_b32 v10, 2, v5
  v_and_b32 v10, 3, v10
  v_xor_b32 v7, v7, v10
  v_lshlrev_b32 v7, 4, v7
  v_lshlrev_b32 v5, 6, v5
  v_add3_u32 v5, v5, v7, v9
  s_mov_b32 s54, 9703424
  buffer_store_dwordx4 v[116:119], v5, s[44:47], s54 offen
L_prep_o_31:
  s_mov_b64 exec, -1
  s_endpgm
L_k1_exit:
  s_endpgm
.globl k2_kernel
.p2align 8
.type k2_kernel,@function
k2_kernel:
  s_cmp_ge_u32 s2, 512
  s_cbranch_scc1 L_k2_exit
  s_cmp_ge_u32 s2, 256
  s_cbranch_scc1 L_k2_a
  s_setprio 3
  s_load_dwordx2 s[4:5], s[0:1], 112
  v_and_b32 v1, 63, v0
  v_lshrrev_b32 v3, 6, v0
  v_lshlrev_b32 v2, 4, v1
  v_readfirstlane_b32 s14, v3
  s_and_b32 s12, s2, 7
  s_lshr_b32 s13, s2, 3
  s_and_b32 s13, s13, 3
  s_lshl_b32 s13, s13, 3
  s_add_u32 s12, s12, s13
  s_lshr_b32 s13, s2, 5
  s_mul_i32 s15, s12, 155648
  s_add_u32 s15, s15, 2359296
  s_and_b32 s19, s14, 3
  s_lshr_b32 s23, s14, 2
  s_lshl_b32 s17, s23, 5
  s_add_u32 s17, s17, s19
  s_mul_i32 s17, s17, 2432
  s_add_u32 s17, s17, s15
  s_mul_i32 s18, s14, 2432
  s_lshl_b32 s21, s13, 3
  s_lshl_b32 s40, s19, 1
  s_add_u32 s21, s21, s40
  s_lshl_b32 s22, s12, 6
  s_add_u32 s22, s22, s21
  s_mul_i32 s22, s22, 1152
  s_lshl_b32 s40, s12, 6
  v_and_b32 v3, 31, v1
  v_lshlrev_b32 v10, 2, v3
  s_waitcnt lgkmcnt(0)
  s_mov_b32 s8, s4
  s_and_b32 s9, s5, 0xffff
  s_mov_b32 s10, 20262912
  s_mov_b32 s11, 0x20000
  s_mov_b32 m0, s18
  s_mov_b64 exec, 0xffffff
  buffer_load_dwordx4 v2, s[8:11], s17 offen offset:2048 lds
  s_mov_b64 exec, -1
  buffer_load_dwordx4 v2, s[8:11], s17 offen lds
  buffer_load_dwordx4 v2, s[8:11], s17 offen offset:1024 lds
  s_add_u32 s17, s17, 9728
  s_add_u32 s18, s18, 19456
  buffer_load_dwordx4 v[12:15], v2, s[8:11], s22 offen
  buffer_load_dword v20, v10, s[8:11], s22 offen offset:1024
  buffer_load_dwordx4 v[16:19], v2, s[8:11], s22 offen offset:1152
  buffer_load_dword v24, v10, s[8:11], s22 offen offset:2176
  s_add_u32 s6, s4, s40
  s_addc_u32 s7, s5, 0
  s_add_u32 s6, s6, 7340032
  s_addc_u32 s7, s7, 0
  s_load_dwordx16 s[24:39], s[6:7], 0
  s_mul_i32 s41, s23, 9728
  v_add_u32 v9, s41, v2
  v_add_u32 v10, 1024, v10
  v_add_u32 v10, s41, v10
  v_min_u32 v5, 19, v3
  v_lshlrev_b32 v5, 4, v5
  v_lshrrev_b32 v4, 5, v1
  v_mul_u32_u24 v4, 320, v4
  v_add_u32 v11, v5, v4
  v_add_u32 v11, 1152, v11
  v_add_u32 v8, s41, v11
  v_mov_b32 v6, v9
  v_mov_b32 v7, v10
  s_mov_b32 s20, 0
  s_lshl_b32 s41, s23, 2
  s_add_u32 s41, s41, 77824
  v_mov_b32 v60, s41
  s_mul_i32 s41, s23, 9728
  v_mov_b32 v33, 0x3f80
  v_mov_b32 v34, 0
  v_mov_b32 v35, 0
  v_mov_b32 v64, 0
  v_mov_b32 v65, 0
  v_mov_b32 v66, 0
  v_mov_b32 v67, 0
  v_mov_b32 v68, 0
  v_mov_b32 v69, 0
  v_mov_b32 v70, 0
  v_mov_b32 v71, 0
  v_mov_b32 v72, 0
  v_mov_b32 v73, 0
  v_mov_b32 v74, 0
  v_mov_b32 v75, 0
  v_mov_b32 v76, 0
  v_mov_b32 v77, 0
  v_mov_b32 v78, 0
  v_mov_b32 v79, 0
  v_mov_b32 v22, 0
  v_mov_b32 v23, 0
  v_mov_b32 v80, 0
  v_mov_b32 v81, 0
  v_mov_b32 v82, 0
  v_mov_b32 v83, 0
  v_mov_b32 v84, 0
  v_mov_b32 v85, 0
  v_mov_b32 v86, 0
  v_mov_b32 v87, 0
  v_mov_b32 v88, 0
  v_mov_b32 v89, 0
  v_mov_b32 v90, 0
  v_mov_b32 v91, 0
  v_mov_b32 v92, 0
  v_mov_b32 v93, 0
  v_mov_b32 v94, 0
  v_mov_b32 v95, 0
  v_mov_b32 v26, 0
  v_mov_b32 v27, 0
  v_mov_b32 v48, 0
  v_mov_b32 v56, 0
  v_mov_b32 v49, 0
  v_mov_b32 v57, 0
  v_mov_b32 v50, 0
  v_mov_b32 v58, 0
  v_mov_b32 v51, 0
  v_mov_b32 v59, 0
  s_waitcnt lgkmcnt(0)
  s_max_u32 s24, s24, s25
  s_max_u32 s24, s24, s26
  s_max_u32 s24, s24, s27
  s_max_u32 s24, s24, s28
  s_max_u32 s24, s24, s29
  s_max_u32 s24, s24, s30
  s_max_u32 s24, s24, s31
  s_max_u32 s24, s24, s32
  s_max_u32 s24, s24, s33
  s_max_u32 s24, s24, s34
  s_max_u32 s24, s24, s35
  s_max_u32 s24, s24, s36
  s_max_u32 s24, s24, s37
  s_max_u32 s24, s24, s38
  s_max_u32 s24, s24, s39
  s_waitcnt vmcnt(0)
  v_cmp_gt_u32 vcc, 32, v1
  v_mov_b32 v4, 0
  s_nop 0
  v_cndmask_b32 v20, v4, v20, vcc
  v_cndmask_b32 v24, v4, v24, vcc
  v_mov_b32 v52, 0
  v_mov_b32 v53, 0
  v_dot2_f32_bf16 v52, v12, v12, v52
  v_dot2_f32_bf16 v53, v16, v16, v53
  v_dot2_f32_bf16 v52, v13, v13, v52
  v_dot2_f32_bf16 v53, v17, v17, v53
  v_dot2_f32_bf16 v52, v14, v14, v52
  v_dot2_f32_bf16 v53, v18, v18, v53
  v_dot2_f32_bf16 v52, v15, v15, v52
  v_dot2_f32_bf16 v53, v19, v19, v53
  v_dot2_f32_bf16 v52, v20, v20, v52
  v_dot2_f32_bf16 v53, v24, v24, v53
  s_nop 2
  v_mov_b32 v54, v52
  v_mov_b32 v55, v53
  s_nop 1
  v_permlane32_swap_b32 v52, v54
  v_permlane32_swap_b32 v53, v55
  s_nop 1
  v_add_f32 v52, v52, v54
  v_add_f32 v53, v53, v55
  v_mul_f32 v52, s24, v52
  v_mul_f32 v53, s24, v53
  v_sqrt_f32 v52, v52
  v_sqrt_f32 v53, v53
  s_nop 0
  v_mul_f32 v52, 0x3f810000, v52
  v_mul_f32 v53, 0x3f810000, v53
  v_add_u32 v52, 0xffff, v52
  v_add_u32 v53, 0xffff, v53
  v_lshrrev_b32 v52, 16, v52
  v_lshrrev_b32 v53, 16, v53
  v_or_b32 v52, 0x8000, v52
  v_or_b32 v53, 0x8000, v53
  v_cndmask_b32 v21, v4, v52, vcc
  v_cndmask_b32 v25, v4, v53, vcc
  v_mov_b32 v3, 0
  ds_write_b32 v60, v3
  s_waitcnt lgkmcnt(0)
  s_mov_b32 s55, 4
  v_mov_b32 v5, 1
  s_barrier
  ds_read_b128 v[28:31], v6
  ds_read_b32 v32, v7
  ds_read_b128 v[36:39], v8
  ds_read_b128 v[44:47], v8 offset:640
  s_waitcnt lgkmcnt(0)
  v_mfma_f32_32x32x16_bf16 v[96:111], v[28:31], v[12:15], 0
  v_mfma_f32_32x32x16_bf16 v[96:111], v[32:35], v[20:23], v[96:111]
  s_mov_b32 s16, 0
  s_mov_b32 m0, s18
  s_mov_b64 exec, 0xffffff
  buffer_load_dwordx4 v2, s[8:11], s17 offen offset:2048 lds
  s_mov_b64 exec, -1
  buffer_load_dwordx4 v2, s[8:11], s17 offen lds
  buffer_load_dwordx4 v2, s[8:11], s17 offen offset:1024 lds
  s_add_u32 s17, s17, 9728
  s_add_u32 s18, s18, 19456
  s_mov_b32 m0, s18
  s_mov_b64 exec, 0xffffff
  buffer_load_dwordx4 v2, s[8:11], s17 offen offset:2048 lds
  s_mov_b64 exec, -1
  buffer_load_dwordx4 v2, s[8:11], s17 offen lds
  buffer_load_dwordx4 v2, s[8:11], s17 offen offset:1024 lds
  s_add_u32 s17, s17, 9728
  s_add_u32 s18, s18, 19456
  s_nop 7
  v_add_u32 v11, s41, v11
  s_setprio 2
L_attn_stage_32:
  s_cmp_lt_u32 s16, 5
  s_mov_b32 m0, s18
  v_mfma_f32_32x32x16_bf16 v[112:127], v[28:31], v[16:19], 0
  s_cbranch_scc0 L_skipdma_37
  s_mov_b64 exec, 0xffffff
  buffer_load_dwordx4 v2, s[8:11], s17 offen offset:2048 lds
  s_mov_b64 exec, -1
L_skipdma_37:
  v_exp_f32 v96, v96
  v_exp_f32 v97, v97
  v_exp_f32 v98, v98
  v_exp_f32 v99, v99
  v_cvt_pk_bf16_f32 v52, v96, v97
  v_cvt_pk_bf16_f32 v53, v98, v99
  v_mfma_f32_32x32x16_bf16 v[112:127], v[32:35], v[24:27], v[112:127]
  v_exp_f32 v100, v100
  v_exp_f32 v101, v101
  v_exp_f32 v102, v102
  v_exp_f32 v103, v103
  v_cvt_pk_bf16_f32 v54, v100, v101
  v_cvt_pk_bf16_f32 v55, v102, v103
  v_mfma_f32_32x32x16_bf16 v[80:95], v[48:51], v[56:59], v[80:95]
  ds_read_b128 v[28:31], v6 offset:2432
  ds_read_b32 v32, v7 offset:2432
  ds_read_b128 v[40:43], v8 offset:2432
  ds_read_b128 v[48:51], v8 offset:3072
  v_exp_f32 v104, v104
  v_exp_f32 v105, v105
  v_exp_f32 v106, v106
  v_exp_f32 v107, v107
  v_cvt_pk_bf16_f32 v56, v104, v105
  v_cvt_pk_bf16_f32 v57, v106, v107
  v_mfma_f32_32x32x16_bf16 v[64:79], v[36:39], v[52:55], v[64:79]
  v_exp_f32 v108, v108
  v_exp_f32 v109, v109
  v_exp_f32 v110, v110
  v_exp_f32 v111, v111
  v_cvt_pk_bf16_f32 v58, v108, v109
  v_cvt_pk_bf16_f32 v59, v110, v111
  s_waitcnt lgkmcnt(0)
  v_mfma_f32_32x32x16_bf16 v[96:111], v[28:31], v[12:15], 0
  v_exp_f32 v112, v112
  v_exp_f32 v113, v113
  v_exp_f32 v114, v114
  v_exp_f32 v115, v115
  v_cvt_pk_bf16_f32 v52, v112, v113
  v_cvt_pk_bf16_f32 v53, v114, v115
  v_mfma_f32_32x32x16_bf16 v[96:111], v[32:35], v[20:23], v[96:111]
  v_exp_f32 v116, v116
  v_exp_f32 v117, v117
  v_exp_f32 v118, v118
  v_exp_f32 v119, v119
  v_cvt_pk_bf16_f32 v54, v116, v117
  v_cvt_pk_bf16_f32 v55, v118, v119
  v_mfma_f32_32x32x16_bf16 v[64:79], v[44:47], v[56:59], v[64:79]
  v_exp_f32 v120, v120
  v_exp_f32 v121, v121
  v_exp_f32 v122, v122
  v_exp_f32 v123, v123
  v_cvt_pk_bf16_f32 v56, v120, v121
  v_cvt_pk_bf16_f32 v57, v122, v123
  v_mfma_f32_32x32x16_bf16 v[80:95], v[36:39], v[52:55], v[80:95]
  v_exp_f32 v124, v124
  v_exp_f32 v125, v125
  v_exp_f32 v126, v126
  v_exp_f32 v127, v127
  v_cvt_pk_bf16_f32 v58, v124, v125
  v_cvt_pk_bf16_f32 v59, v126, v127
  s_setprio 2
  v_mfma_f32_32x32x16_bf16 v[112:127], v[28:31], v[16:19], 0
  s_cbranch_scc0 L_skipdma_38
  buffer_load_dwordx4 v2, s[8:11], s17 offen offset:0 lds
L_skipdma_38:
  v_exp_f32 v96, v96
  v_exp_f32 v97, v97
  v_exp_f32 v98, v98
  v_exp_f32 v99, v99
  v_cvt_pk_bf16_f32 v52, v96, v97
  v_cvt_pk_bf16_f32 v53, v98, v99
  v_mfma_f32_32x32x16_bf16 v[112:127], v[32:35], v[24:27], v[112:127]
  v_exp_f32 v100, v100
  v_exp_f32 v101, v101
  v_exp_f32 v102, v102
  v_exp_f32 v103, v103
  v_cvt_pk_bf16_f32 v54, v100, v101
  v_cvt_pk_bf16_f32 v55, v102, v103
  v_mfma_f32_32x32x16_bf16 v[80:95], v[44:47], v[56:59], v[80:95]
  ds_read_b128 v[28:31], v6 offset:4864
  ds_read_b32 v32, v7 offset:4864
  ds_read_b128 v[36:39], v8 offset:4864
  ds_read_b128 v[44:47], v8 offset:5504
  v_exp_f32 v104, v104
  v_exp_f32 v105, v105
  v_exp_f32 v106, v106
  v_exp_f32 v107, v107
  v_cvt_pk_bf16_f32 v56, v104, v105
  v_cvt_pk_bf16_f32 v57, v106, v107
  v_mfma_f32_32x32x16_bf16 v[64:79], v[40:43], v[52:55], v[64:79]
  v_exp_f32 v108, v108
  v_exp_f32 v109, v109
  v_exp_f32 v110, v110
  v_exp_f32 v111, v111
  v_cvt_pk_bf16_f32 v58, v108, v109
  v_cvt_pk_bf16_f32 v59, v110, v111
  s_waitcnt lgkmcnt(0)
  v_mfma_f32_32x32x16_bf16 v[96:111], v[28:31], v[12:15], 0
  v_exp_f32 v112, v112
  v_exp_f32 v113, v113
  v_exp_f32 v114, v114
  v_exp_f32 v115, v115
  v_cvt_pk_bf16_f32 v52, v112, v113
  v_cvt_pk_bf16_f32 v53, v114, v115
  v_mfma_f32_32x32x16_bf16 v[96:111], v[32:35], v[20:23], v[96:111]
  v_exp_f32 v116, v116
  v_exp_f32 v117, v117
  v_exp_f32 v118, v118
  v_exp_f32 v119, v119
  v_cvt_pk_bf16_f32 v54, v116, v117
  v_cvt_pk_bf16_f32 v55, v118, v119
  v_mfma_f32_32x32x16_bf16 v[64:79], v[48:51], v[56:59], v[64:79]
  v_exp_f32 v120, v120
  v_exp_f32 v121, v121
  v_exp_f32 v122, v122
  v_exp_f32 v123, v123
  v_cvt_pk_bf16_f32 v56, v120, v121
  v_cvt_pk_bf16_f32 v57, v122, v123
  v_mfma_f32_32x32x16_bf16 v[80:95], v[40:43], v[52:55], v[80:95]
  v_exp_f32 v124, v124
  v_exp_f32 v125, v125
  v_exp_f32 v126, v126
  v_exp_f32 v127, v127
  v_cvt_pk_bf16_f32 v58, v124, v125
  v_cvt_pk_bf16_f32 v59, v126, v127
  s_setprio 1
  v_mfma_f32_32x32x16_bf16 v[112:127], v[28:31], v[16:19], 0
  s_cbranch_scc0 L_skipdma_39
  buffer_load_dwordx4 v2, s[8:11], s17 offen offset:1024 lds
L_skipdma_39:
  v_exp_f32 v96, v96
  v_exp_f32 v97, v97
  v_exp_f32 v98, v98
  v_exp_f32 v99, v99
  v_cvt_pk_bf16_f32 v52, v96, v97
  v_cvt_pk_bf16_f32 v53, v98, v99
  v_mfma_f32_32x32x16_bf16 v[112:127], v[32:35], v[24:27], v[112:127]
  v_exp_f32 v100, v100
  v_exp_f32 v101, v101
  v_exp_f32 v102, v102
  v_exp_f32 v103, v103
  v_cvt_pk_bf16_f32 v54, v100, v101
  v_cvt_pk_bf16_f32 v55, v102, v103
  v_mfma_f32_32x32x16_bf16 v[80:95], v[48:51], v[56:59], v[80:95]
  ds_read_b128 v[28:31], v6 offset:7296
  ds_read_b32 v32, v7 offset:7296
  ds_read_b128 v[40:43], v8 offset:7296
  ds_read_b128 v[48:51], v8 offset:7936
  v_exp_f32 v104, v104
  v_exp_f32 v105, v105
  v_exp_f32 v106, v106
  v_exp_f32 v107, v107
  v_cvt_pk_bf16_f32 v56, v104, v105
  v_cvt_pk_bf16_f32 v57, v106, v107
  v_mfma_f32_32x32x16_bf16 v[64:79], v[36:39], v[52:55], v[64:79]
  v_exp_f32 v108, v108
  v_exp_f32 v109, v109
  v_exp_f32 v110, v110
  v_exp_f32 v111, v111
  v_cvt_pk_bf16_f32 v58, v108, v109
  v_cvt_pk_bf16_f32 v59, v110, v111
  s_waitcnt lgkmcnt(0)
  v_mfma_f32_32x32x16_bf16 v[96:111], v[28:31], v[12:15], 0
  v_exp_f32 v112, v112
  v_exp_f32 v113, v113
  v_exp_f32 v114, v114
  v_exp_f32 v115, v115
  v_cvt_pk_bf16_f32 v52, v112, v113
  v_cvt_pk_bf16_f32 v53, v114, v115
  v_mfma_f32_32x32x16_bf16 v[96:111], v[32:35], v[20:23], v[96:111]
  s_cmp_lt_u32 s16, 5
  s_cbranch_scc1 L_w6_40
  s_waitcnt vmcnt(0)
L_w6_40:
  s_waitcnt vmcnt(6)
  s_mov_b64 exec, 1
  ds_add_u32 v60, v5
  s_mov_b64 exec, -1
  v_exp_f32 v116, v116
  v_exp_f32 v117, v117
  v_exp_f32 v118, v118
  v_exp_f32 v119, v119
  v_cvt_pk_bf16_f32 v54, v116, v117
  v_cvt_pk_bf16_f32 v55, v118, v119
  v_mfma_f32_32x32x16_bf16 v[64:79], v[44:47], v[56:59], v[64:79]
  v_exp_f32 v120, v120
  v_exp_f32 v121, v121
  v_exp_f32 v122, v122
  v_exp_f32 v123, v123
  v_cvt_pk_bf16_f32 v56, v120, v121
  v_cvt_pk_bf16_f32 v57, v122, v123
  v_mfma_f32_32x32x16_bf16 v[80:95], v[36:39], v[52:55], v[80:95]
  v_exp_f32 v124, v124
  v_exp_f32 v125, v125
  v_exp_f32 v126, v126
  v_exp_f32 v127, v127
  v_cvt_pk_bf16_f32 v58, v124, v125
  v_cvt_pk_bf16_f32 v59, v126, v127
  s_setprio 0
  v_mfma_f32_32x32x16_bf16 v[112:127], v[28:31], v[16:19], 0
  v_exp_f32 v96, v96
  v_exp_f32 v97, v97
  v_exp_f32 v98, v98
  v_exp_f32 v99, v99
  v_cvt_pk_bf16_f32 v52, v96, v97
  v_cvt_pk_bf16_f32 v53, v98, v99
  v_mfma_f32_32x32x16_bf16 v[112:127], v[32:35], v[24:27], v[112:127]
  ds_read_b32 v4, v60
  v_exp_f32 v100, v100
  v_exp_f32 v101, v101
  v_exp_f32 v102, v102
  v_exp_f32 v103, v103
  v_cvt_pk_bf16_f32 v54, v100, v101
  v_cvt_pk_bf16_f32 v55, v102, v103
  v_mfma_f32_32x32x16_bf16 v[80:95], v[44:47], v[56:59], v[80:95]
  s_waitcnt lgkmcnt(0)
  v_readfirstlane_b32 s40, v4
  s_cmp_ge_u32 s40, s55
  s_cbranch_scc1 L_hb_ok_41
L_hb_spin_42:
  ds_read_b32 v4, v60
  s_waitcnt lgkmcnt(0)
  v_readfirstlane_b32 s40, v4
  s_cmp_ge_u32 s40, s55
  s_cbranch_scc0 L_hb_spin_42
L_hb_ok_41:
  s_add_u32 s55, s55, 4
  s_add_u32 s17, s17, 9728
  s_add_u32 s18, s18, 19456
  s_sub_u32 s40, s18, 77824
  s_cmp_ge_u32 s18, 77824
  s_cselect_b32 s18, s40, s18
  s_setprio 2
  s_add_u32 s20, s20, 19456
  s_cmp_ge_u32 s20, 77824
  s_cselect_b32 s20, 0, s20
  v_add_u32 v6, s20, v9
  v_add_u32 v7, s20, v10
  v_add_u32 v8, s20, v11
  ds_read_b128 v[28:31], v6 offset:0
  ds_read_b32 v32, v7 offset:0
  ds_read_b128 v[36:39], v8 offset:0
  ds_read_b128 v[44:47], v8 offset:640
  v_exp_f32 v104, v104
  v_exp_f32 v105, v105
  v_exp_f32 v106, v106
  v_exp_f32 v107, v107
  v_cvt_pk_bf16_f32 v56, v104, v105
  v_cvt_pk_bf16_f32 v57, v106, v107
  v_mfma_f32_32x32x16_bf16 v[64:79], v[40:43], v[52:55], v[64:79]
  v_exp_f32 v108, v108
  v_exp_f32 v109, v109
  v_exp_f32 v110, v110
  v_exp_f32 v111, v111
  v_cvt_pk_bf16_f32 v58, v108, v109
  v_cvt_pk_bf16_f32 v59, v110, v111
  s_waitcnt lgkmcnt(0)
  v_mfma_f32_32x32x16_bf16 v[96:111], v[28:31], v[12:15], 0
  v_exp_f32 v112, v112
  v_exp_f32 v113, v113
  v_exp_f32 v114, v114
  v_exp_f32 v115, v115
  v_cvt_pk_bf16_f32 v52, v112, v113
  v_cvt_pk_bf16_f32 v53, v114, v115
  v_mfma_f32_32x32x16_bf16 v[96:111], v[32:35], v[20:23], v[96:111]
  v_exp_f32 v116, v116
  v_exp_f32 v117, v117
  v_exp_f32 v118, v118
  v_exp_f32 v119, v119
  v_cvt_pk_bf16_f32 v54, v116, v117
  v_cvt_pk_bf16_f32 v55, v118, v119
  v_mfma_f32_32x32x16_bf16 v[64:79], v[48:51], v[56:59], v[64:79]
  v_exp_f32 v120, v120
  v_exp_f32 v121, v121
  v_exp_f32 v122, v122
  v_exp_f32 v123, v123
  v_cvt_pk_bf16_f32 v56, v120, v121
  v_cvt_pk_bf16_f32 v57, v122, v123
  v_mfma_f32_32x32x16_bf16 v[80:95], v[40:43], v[52:55], v[80:95]
  v_exp_f32 v124, v124
  v_exp_f32 v125, v125
  v_exp_f32 v126, v126
  v_exp_f32 v127, v127
  v_cvt_pk_bf16_f32 v58, v124, v125
  v_cvt_pk_bf16_f32 v59, v126, v127
  s_add_u32 s16, s16, 1
  s_cmp_lt_u32 s16, 8
  s_cbranch_scc1 L_attn_stage_32
  s_nop 1
  v_mfma_f32_32x32x16_bf16 v[80:95], v[48:51], v[56:59], v[80:95]
  s_setprio 0
  s_nop 15
  s_nop 3
  s_barrier
  s_mul_i32 s40, s19, 5632
  v_lshlrev_b32 v3, 2, v1
  v_add_u32 v3, s40, v3
  s_cmp_eq_u32 s23, 1
  s_cbranch_scc1 L_attn_hi_43
  ds_write_b32 v3, v80 offset:2816
  ds_write_b32 v3, v81 offset:3072
  ds_write_b32 v3, v82 offset:3328
  ds_write_b32 v3, v83 offset:3584
  ds_write_b32 v3, v84 offset:3840
  ds_write_b32 v3, v85 offset:4096
  ds_write_b32 v3, v86 offset:4352
  ds_write_b32 v3, v87 offset:4608
  ds_write_b32 v3, v88 offset:4864
  ds_write_b32 v3, v89 offset:5120
  ds_write_b32 v3, v90 offset:5376
  s_waitcnt lgkmcnt(0)
  s_barrier
  ds_read_b32 v96, v3 offset:0
  ds_read_b32 v97, v3 offset:256
  ds_read_b32 v98, v3 offset:512
  ds_read_b32 v99, v3 offset:768
  ds_read_b32 v100, v3 offset:1024
  ds_read_b32 v101, v3 offset:1280
  ds_read_b32 v102, v3 offset:1536
  ds_read_b32 v103, v3 offset:1792
  ds_read_b32 v104, v3 offset:2048
  ds_read_b32 v105, v3 offset:2304
  ds_read_b32 v106, v3 offset:2560
  s_waitcnt lgkmcnt(0)
  v_add_f32 v64, v64, v96
  v_add_f32 v65, v65, v97
  v_add_f32 v66, v66, v98
  v_add_f32 v67, v67, v99
  v_add_f32 v68, v68, v100
  v_add_f32 v69, v69, v101
  v_add_f32 v70, v70, v102
  v_add_f32 v71, v71, v103
  v_add_f32 v72, v72, v104
  v_add_f32 v73, v73, v105
  v_add_f32 v74, v74, v106
  s_branch L_attn_x_44
L_attn_hi_43:
  ds_write_b32 v3, v64 offset:0
  ds_write_b32 v3, v65 offset:256
  ds_write_b32 v3, v66 offset:512
  ds_write_b32 v3, v67 offset:768
  ds_write_b32 v3, v68 offset:1024
  ds_write_b32 v3, v69 offset:1280
  ds_write_b32 v3, v70 offset:1536
  ds_write_b32 v3, v71 offset:1792
  ds_write_b32 v3, v72 offset:2048
  ds_write_b32 v3, v73 offset:2304
  ds_write_b32 v3, v74 offset:2560
  s_waitcnt lgkmcnt(0)
  s_barrier
  ds_read_b32 v96, v3 offset:2816
  ds_read_b32 v97, v3 offset:3072
  ds_read_b32 v98, v3 offset:3328
  ds_read_b32 v99, v3 offset:3584
  ds_read_b32 v100, v3 offset:3840
  ds_read_b32 v101, v3 offset:4096
  ds_read_b32 v102, v3 offset:4352
  ds_read_b32 v103, v3 offset:4608
  ds_read_b32 v104, v3 offset:4864
  ds_read_b32 v105, v3 offset:5120
  ds_read_b32 v106, v3 offset:5376
  s_waitcnt lgkmcnt(0)
  v_add_f32 v64, v80, v96
  v_add_f32 v65, v81, v97
  v_add_f32 v66, v82, v98
  v_add_f32 v67, v83, v99
  v_add_f32 v68, v84, v100
  v_add_f32 v69, v85, v101
  v_add_f32 v70, v86, v102
  v_add_f32 v71, v87, v103
  v_add_f32 v72, v88, v104
  v_add_f32 v73, v89, v105
  v_add_f32 v74, v90, v106
  v_mov_b32 v12, v16
  v_mov_b32 v13, v17
  v_mov_b32 v14, v18
  v_mov_b32 v15, v19
  v_mov_b32 v20, v24
  s_add_u32 s21, s21, 1
L_attn_x_44:
  v_mov_b32 v3, v74
  v_mov_b32 v4, v74
  s_nop 1
  v_permlane32_swap_b32 v3, v4
  s_nop 1
  v_mov_b32 v4, 0x21800000
  v_cmp_nge_f32 vcc, v3, v4
  s_nop 1
  s_cbranch_vccnz L_attn_fallback_35
L_attn_store_36:
  v_rcp_f32 v3, v3
  s_nop 0
  v_mul_f32 v64, v64, v3
  v_mul_f32 v65, v65, v3
  v_mul_f32 v66, v66, v3
  v_mul_f32 v67, v67, v3
  v_mul_f32 v68, v68, v3
  v_mul_f32 v69, v69, v3
  v_mul_f32 v70, v70, v3
  v_mul_f32 v71, v71, v3
  v_mul_f32 v72, v72, v3
  v_mul_f32 v73, v73, v3
  v_cvt_pk_bf16_f32 v52, v64, v65
  v_cvt_pk_bf16_f32 v53, v66, v67
  v_cvt_pk_bf16_f32 v54, v68, v69
  v_cvt_pk_bf16_f32 v55, v70, v71
  v_cvt_pk_bf16_f32 v56, v72, v73
  v_and_b32 v3, 31, v1
  v_lshrrev_b32 v4, 3, v3
  v_and_b32 v4, 1, v4
  v_lshlrev_b32 v3, 5, v3
  s_lshr_b32 s40, s21, 2
  s_mul_i32 s40, s40, 147456
  s_and_b32 s41, s21, 3
  s_lshl_b32 s41, s41, 10
  s_add_u32 s40, s40, s41
  s_add_u32 s40, s40, 7344128
  v_lshrrev_b32 v5, 5, v1
  v_xor_b32 v5, v5, v4
  v_lshlrev_b32 v5, 4, v5
  v_add_u32 v5, v5, v3
  s_lshl_b32 s41, s12, 12
  s_add_u32 s41, s41, s40
  buffer_store_dwordx4 v[52:55], v5, s[8:11], s41 offen sc1
  v_lshrrev_b32 v4, 3, v3
  s_lshr_b32 s41, s21, 2
  s_mul_i32 s41, s41, 147456
  s_add_u32 s41, s41, 7475200
  s_lshl_b32 s42, s12, 9
  s_add_u32 s41, s41, s42
  s_and_b32 s42, s21, 3
  s_lshl_b32 s42, s42, 7
  s_add_u32 s41, s41, s42
  s_mov_b32 exec_hi, 0
  buffer_store_dword v56, v4, s[8:11], s41 offen sc1
  s_mov_b64 exec, -1
  s_endpgm
L_attn_fallback_35:
  v_mov_b32 v21, 0
  v_mov_b32 v6, 0xff800000
  v_and_b32 v3, 31, v1
  v_lshlrev_b32 v10, 2, v3
  s_mul_i32 s41, s23, 9728
  v_subrev_u32 v11, s41, v11
  s_mov_b32 s40, s15
  s_mov_b32 s16, 0
L_fb_p1_45:
  buffer_load_dwordx4 v[28:31], v2, s[8:11], s40 offen
  buffer_load_dword v32, v10, s[8:11], s40 offen offset:1024
  s_waitcnt vmcnt(0)
  v_mfma_f32_32x32x16_bf16 v[96:111], v[28:31], v[12:15], 0
  v_mfma_f32_32x32x16_bf16 v[96:111], v[32:35], v[20:23], v[96:111]
  s_nop 15
  s_nop 3
  v_max3_f32 v6, v6, v96, v97
  v_max3_f32 v6, v6, v98, v99
  v_max3_f32 v6, v6, v100, v101
  v_max3_f32 v6, v6, v102, v103
  v_max3_f32 v6, v6, v104, v105
  v_max3_f32 v6, v6, v106, v107
  v_max3_f32 v6, v6, v108, v109
  v_max3_f32 v6, v6, v110, v111
  s_add_u32 s40, s40, 2432
  s_add_u32 s16, s16, 1
  s_cmp_lt_u32 s16, 64
  s_cbranch_scc1 L_fb_p1_45
  v_mov_b32 v3, v6
  s_nop 1
  v_permlane32_swap_b32 v6, v3
  s_nop 1
  v_max_f32 v6, v6, v3
  v_mov_b32 v64, 0
  v_mov_b32 v65, 0
  v_mov_b32 v66, 0
  v_mov_b32 v67, 0
  v_mov_b32 v68, 0
  v_mov_b32 v69, 0
  v_mov_b32 v70, 0
  v_mov_b32 v71, 0
  v_mov_b32 v72, 0
  v_mov_b32 v73, 0
  v_mov_b32 v74, 0
  v_mov_b32 v75, 0
  v_mov_b32 v76, 0
  v_mov_b32 v77, 0
  v_mov_b32 v78, 0
  v_mov_b32 v79, 0
  s_mov_b32 s40, s15
  s_mov_b32 s16, 0
L_fb_p2_46:
  buffer_load_dwordx4 v[28:31], v2, s[8:11], s40 offen
  buffer_load_dword v32, v10, s[8:11], s40 offen offset:1024
  buffer_load_dwordx4 v[36:39], v11, s[8:11], s40 offen
  buffer_load_dwordx4 v[44:47], v11, s[8:11], s40 offen offset:640
  s_waitcnt vmcnt(0)
  v_mfma_f32_32x32x16_bf16 v[96:111], v[28:31], v[12:15], 0
  v_mfma_f32_32x32x16_bf16 v[96:111], v[32:35], v[20:23], v[96:111]
  s_nop 15
  s_nop 3
  v_sub_f32 v96, v96, v6
  v_sub_f32 v97, v97, v6
  v_sub_f32 v98, v98, v6
  v_sub_f32 v99, v99, v6
  v_sub_f32 v100, v100, v6
  v_sub_f32 v101, v101, v6
  v_sub_f32 v102, v102, v6
  v_sub_f32 v103, v103, v6
  v_sub_f32 v104, v104, v6
  v_sub_f32 v105, v105, v6
  v_sub_f32 v106, v106, v6
  v_sub_f32 v107, v107, v6
  v_sub_f32 v108, v108, v6
  v_sub_f32 v109, v109, v6
  v_sub_f32 v110, v110, v6
  v_sub_f32 v111, v111, v6
  v_exp_f32 v96, v96
  v_exp_f32 v97, v97
  v_exp_f32 v98, v98
  v_exp_f32 v99, v99
  v_exp_f32 v100, v100
  v_exp_f32 v101, v101
  v_exp_f32 v102, v102
  v_exp_f32 v103, v103
  v_exp_f32 v104, v104
  v_exp_f32 v105, v105
  v_exp_f32 v106, v106
  v_exp_f32 v107, v107
  v_exp_f32 v108, v108
  v_exp_f32 v109, v109
  v_exp_f32 v110, v110
  v_exp_f32 v111, v111
  s_nop 0
  v_cvt_pk_bf16_f32 v52, v96, v97
  v_cvt_pk_bf16_f32 v53, v98, v99
  v_cvt_pk_bf16_f32 v54, v100, v101
  v_cvt_pk_bf16_f32 v55, v102, v103
  v_cvt_pk_bf16_f32 v56, v104, v105
  v_cvt_pk_bf16_f32 v57, v106, v107
  v_cvt_pk_bf16_f32 v58, v108, v109
  v_cvt_pk_bf16_f32 v59, v110, v111
  s_nop 1
  v_mfma_f32_32x32x16_bf16 v[64:79], v[36:39], v[52:55], v[64:79]
  v_mfma_f32_32x32x16_bf16 v[64:79], v[44:47], v[56:59], v[64:79]
  s_add_u32 s40, s40, 2432
  s_add_u32 s16, s16, 1
  s_cmp_lt_u32 s16, 64
  s_cbranch_scc1 L_fb_p2_46
  s_nop 15
  s_nop 3
  v_mov_b32 v3, v74
  v_mov_b32 v4, v74
  s_nop 1
  v_permlane32_swap_b32 v3, v4
  s_nop 1
  s_branch L_attn_store_36
L_k2_a:
  s_sub_u32 s3, s2, 256
  s_setprio 3
  s_load_dwordx2 s[4:5], s[0:1], 0
  s_load_dwordx4 s[8:11], s[0:1], 8
  s_load_dwordx4 s[12:15], s[0:1], 24
  s_load_dwordx2 s[16:17], s[0:1], 56
  s_load_dwordx4 s[60:63], s[0:1], 104
  s_and_b32 s6, s3, 7
  s_lshr_b32 s7, s3, 3
  v_and_b32 v1, 63, v0
  v_lshrrev_b32 v2, 6, v0
  s_nop 0
  v_readfirstlane_b32 s20, v2
  s_lshr_b32 s19, s20, 2
  s_and_b32 s20, s20, 3
  s_cmp_lt_u32 s7, 4
  s_cbranch_scc1 L_a4_dualsel_49
  s_mov_b32 s57, 0
  s_sub_u32 s18, s7, 4
  s_mul_i32 s21, s18, 7282
  s_lshr_b32 s21, s21, 16
  s_mul_i32 s27, s21, 9
  s_sub_u32 s27, s18, s27
  s_lshl_b32 s21, s21, 3
  s_add_u32 s26, s21, s6
  s_cmp_eq_u32 s7, 31
  s_cbranch_scc0 L_a4_go_50
  s_mov_b32 s27, 8
  s_branch L_a4_go_50
L_a4_dualsel_49:
  s_mov_b32 s57, 1
  s_mov_b32 s27, s6
  s_lshl_b32 s26, s7, 1
  s_add_u32 s26, s26, 24
  s_add_u32 s26, s26, s19
  s_cmp_eq_u32 s57, 1
  s_cbranch_scc0 L_a4_dp_51
  s_cmp_eq_u32 s19, 1
  s_cbranch_scc0 L_a4_dp_51
  s_setprio 2
L_a4_dp_51:
L_a4_go_50:
  s_waitcnt lgkmcnt(0)
  s_mov_b32 s28, s4
  s_and_b32 s29, s5, 0xffff
  s_mov_b32 s30, 2359296
  s_mov_b32 s31, 0x20000
  s_mov_b32 s32, s12
  s_and_b32 s33, s13, 0xffff
  s_mov_b32 s34, 663552
  s_mov_b32 s35, 0x20000
  s_mov_b32 s36, s14
  s_and_b32 s37, s15, 0xffff
  s_mov_b32 s38, 663552
  s_mov_b32 s39, 0x20000
  v_lshrrev_b32 v3, 4, v1
  s_and_b32 s23, s20, 1
  s_lshl_b32 s23, s23, 2
  v_add_u32 v3, s23, v3
  v_and_b32 v2, 7, v1
  v_xor_b32 v2, v2, v3
  v_lshlrev_b32 v2, 4, v2
  v_lshrrev_b32 v3, 3, v1
  v_mul_u32_u24 v4, 1152, v3
  v_add_u32 v48, v4, v2
  v_lshrrev_b32 v4, 2, v3
  v_lshlrev_b32 v4, 4, v4
  v_and_b32 v5, 3, v3
  v_add_u32 v4, v4, v5
  v_mul_u32_u24 v4, 1152, v4
  v_add_u32 v47, v4, v2
  s_lshl_b32 s44, s26, 6
  s_lshl_b32 s45, s20, 2
  s_add_u32 s44, s44, s45
  s_mul_i32 s44, s44, 1152
  s_add_u32 s45, s44, 36864
  s_lshl_b32 s46, s27, 6
  s_lshl_b32 s47, s20, 3
  s_add_u32 s46, s46, s47
  s_mul_i32 s46, s46, 1152
  s_lshl_b32 s58, s20, 10
  s_cmp_eq_u32 s57, 1
  s_cbranch_scc1 L_a4_sc_52
  s_cmp_eq_u32 s19, 1
  s_cbranch_scc1 L_a4_loader_47
L_a4_sc_52:
  s_mov_b32 s40, s8
  s_and_b32 s41, s9, 0xffff
  s_mov_b32 s42, 1152
  s_mov_b32 s43, 0x20000
  s_mov_b32 s48, s10
  s_and_b32 s49, s11, 0xffff
  s_mov_b32 s50, 1152
  s_mov_b32 s51, 0x20000
  s_mov_b32 s52, s16
  s_and_b32 s53, s17, 0xffff
  s_mov_b32 s54, 1152
  s_mov_b32 s55, 0x20000
  s_lshr_b32 s66, s20, 1
  s_and_b32 s67, s20, 1
  s_lshl_b32 s68, s27, 6
  s_lshl_b32 s69, s67, 5
  s_add_u32 s68, s68, s69
  v_and_b32 v40, 31, v1
  v_add_u32 v40, s68, v40
  v_lshlrev_b32 v2, 1, v40
  buffer_load_ushort v44, v2, s[40:43], 0 offen
  buffer_load_ushort v45, v2, s[48:51], 0 offen
  buffer_load_ushort v46, v2, s[52:55], 0 offen
  s_add_u32 s40, s62, 20099072
  s_addc_u32 s41, s63, 0
  s_and_b32 s41, s41, 0xffff
  s_mov_b32 s42, 147456
  s_mov_b32 s43, 0x20000
  s_mul_i32 s69, s26, 576
  v_add_u32 v41, s69, v40
  v_lshlrev_b32 v41, 3, v41
  v_mov_b32 v8, 0
  v_mov_b32 v24, 0
  v_mov_b32 v9, 0
  v_mov_b32 v25, 0
  v_mov_b32 v10, 0
  v_mov_b32 v26, 0
  v_mov_b32 v11, 0
  v_mov_b32 v27, 0
  v_mov_b32 v12, 0
  v_mov_b32 v28, 0
  v_mov_b32 v13, 0
  v_mov_b32 v29, 0
  v_mov_b32 v14, 0
  v_mov_b32 v30, 0
  v_mov_b32 v15, 0
  v_mov_b32 v31, 0
  v_mov_b32 v16, 0
  v_mov_b32 v32, 0
  v_mov_b32 v17, 0
  v_mov_b32 v33, 0
  v_mov_b32 v18, 0
  v_mov_b32 v34, 0
  v_mov_b32 v19, 0
  v_mov_b32 v35, 0
  v_mov_b32 v20, 0
  v_mov_b32 v36, 0
  v_mov_b32 v21, 0
  v_mov_b32 v37, 0
  v_mov_b32 v22, 0
  v_mov_b32 v38, 0
  v_mov_b32 v23, 0
  v_mov_b32 v39, 0
  v_and_b32 v2, 31, v1
  v_lshrrev_b32 v3, 1, v2
  v_and_b32 v3, 7, v3
  v_lshrrev_b32 v4, 5, v1
  v_xor_b32 v3, v3, v4
  v_lshlrev_b32 v3, 4, v3
  v_lshlrev_b32 v2, 7, v2
  v_add_u32 v2, v2, v3
  s_lshl_b32 s69, s66, 12
  s_mul_i32 s70, s19, 8192
  s_mul_i32 s70, s70, s57
  s_add_u32 s69, s69, s70
  v_add_u32 v52, s69, v2
  s_lshl_b32 s69, s67, 12
  s_lshl_b32 s70, s57, 13
  s_add_u32 s70, s70, 8192
  s_add_u32 s69, s69, s70
  v_add_u32 v53, s69, v2
  s_mov_b32 s24, 0
  s_mov_b32 s25, 0
  s_waitcnt lgkmcnt(0)
  s_cmp_eq_u32 s57, 1
  s_cbranch_scc1 L_a4_dual_54
L_a4_sl_56:
  s_barrier
  v_add_u32 v54, s25, v52
  v_add_u32 v55, s25, v53
  ds_read_b128 v[60:63], v54
  ds_read_b128 v[64:67], v55
  ds_read_b128 v[68:71], v55 offset:8192
  s_waitcnt lgkmcnt(0)
  v_mfma_f32_32x32x16_bf16 v[8:23], v[60:63], v[64:67], v[8:23]
  v_mfma_f32_32x32x16_bf16 v[24:39], v[60:63], v[68:71], v[24:39]
  v_xor_b32 v56, 32, v54
  v_xor_b32 v57, 32, v55
  ds_read_b128 v[72:75], v56
  ds_read_b128 v[76:79], v57
  ds_read_b128 v[80:83], v57 offset:8192
  s_waitcnt lgkmcnt(0)
  v_mfma_f32_32x32x16_bf16 v[8:23], v[72:75], v[76:79], v[8:23]
  v_mfma_f32_32x32x16_bf16 v[24:39], v[72:75], v[80:83], v[24:39]
  v_xor_b32 v56, 64, v54
  v_xor_b32 v57, 64, v55
  ds_read_b128 v[84:87], v56
  ds_read_b128 v[88:91], v57
  ds_read_b128 v[92:95], v57 offset:8192
  s_waitcnt lgkmcnt(0)
  v_mfma_f32_32x32x16_bf16 v[8:23], v[84:87], v[88:91], v[8:23]
  v_mfma_f32_32x32x16_bf16 v[24:39], v[84:87], v[92:95], v[24:39]
  v_xor_b32 v56, 96, v54
  v_xor_b32 v57, 96, v55
  ds_read_b128 v[96:99], v56
  ds_read_b128 v[100:103], v57
  ds_read_b128 v[104:107], v57 offset:8192
  s_add_u32 s25, s25, 24576
  s_cmp_ge_u32 s25, 73728
  s_cselect_b32 s25, 0, s25
  s_waitcnt lgkmcnt(0)
  v_mfma_f32_32x32x16_bf16 v[8:23], v[96:99], v[100:103], v[8:23]
  v_mfma_f32_32x32x16_bf16 v[24:39], v[96:99], v[104:107], v[24:39]
  s_add_u32 s24, s24, 1
  s_cmp_lt_u32 s24, 9
  s_cbranch_scc1 L_a4_sl_56
  s_branch L_a4_done_55
L_a4_dual_54:
  s_lshl_b32 s71, s19, 13
  s_add_u32 s71, s71, s58
  s_lshl_b32 s72, s19, 12
  s_add_u32 s72, s72, s58
  s_add_u32 s72, s72, 16384
  s_mul_i32 s73, s19, 36864
  s_add_u32 s46, s46, s73
  s_mov_b32 s22, 0
  s_add_u32 m0, s22, s71
  s_nop 0
  buffer_load_dwordx4 v47, s[28:31], s44 offen lds
  s_add_u32 m0, m0, 4096
  s_add_u32 s44, s44, 128
  buffer_load_dwordx4 v47, s[28:31], s45 offen lds
  s_add_u32 m0, s22, s72
  s_add_u32 s45, s45, 128
  buffer_load_dwordx4 v48, s[32:35], s46 offen lds
  s_add_u32 m0, m0, 8192
  s_nop 0
  buffer_load_dwordx4 v48, s[36:39], s46 offen lds
  s_add_u32 s46, s46, 128
  s_xor_b32 s22, s22, 32768
  s_add_u32 m0, s22, s71
  s_nop 0
  buffer_load_dwordx4 v47, s[28:31], s44 offen lds
  s_add_u32 m0, m0, 4096
  s_add_u32 s44, s44, 128
  buffer_load_dwordx4 v47, s[28:31], s45 offen lds
  s_add_u32 m0, s22, s72
  s_add_u32 s45, s45, 128
  buffer_load_dwordx4 v48, s[32:35], s46 offen lds
  s_add_u32 m0, m0, 8192
  s_nop 0
  buffer_load_dwordx4 v48, s[36:39], s46 offen lds
  s_add_u32 s46, s46, 128
  s_xor_b32 s22, s22, 32768
L_a4_dl_57:
  s_cmp_ge_u32 s24, 8
  s_cbranch_scc0 L_a4_dw_58
  s_waitcnt vmcnt(0)
L_a4_dw_58:
  s_waitcnt vmcnt(4)
  s_barrier
  v_add_u32 v54, s25, v52
  v_add_u32 v55, s25, v53
  ds_read_b128 v[60:63], v54
  ds_read_b128 v[64:67], v55
  ds_read_b128 v[68:71], v55 offset:8192
  s_waitcnt lgkmcnt(0)
  v_mfma_f32_32x32x16_bf16 v[8:23], v[60:63], v[64:67], v[8:23]
  v_mfma_f32_32x32x16_bf16 v[24:39], v[60:63], v[68:71], v[24:39]
  v_xor_b32 v56, 32, v54
  v_xor_b32 v57, 32, v55
  ds_read_b128 v[72:75], v56
  ds_read_b128 v[76:79], v57
  ds_read_b128 v[80:83], v57 offset:8192
  s_waitcnt lgkmcnt(0)
  v_mfma_f32_32x32x16_bf16 v[8:23], v[72:75], v[76:79], v[8:23]
  v_mfma_f32_32x32x16_bf16 v[24:39], v[72:75], v[80:83], v[24:39]
  v_xor_b32 v56, 64, v54
  v_xor_b32 v57, 64, v55
  ds_read_b128 v[84:87], v56
  ds_read_b128 v[88:91], v57
  ds_read_b128 v[92:95], v57 offset:8192
  s_waitcnt lgkmcnt(0)
  v_mfma_f32_32x32x16_bf16 v[8:23], v[84:87], v[88:91], v[8:23]
  v_mfma_f32_32x32x16_bf16 v[24:39], v[84:87], v[92:95], v[24:39]
  v_xor_b32 v56, 96, v54
  v_xor_b32 v57, 96, v55
  ds_read_b128 v[96:99], v56
  ds_read_b128 v[100:103], v57
  ds_read_b128 v[104:107], v57 offset:8192
  s_add_u32 s25, s25, 32768
  s_cmp_ge_u32 s25, 65536
  s_cselect_b32 s25, 0, s25
  s_waitcnt lgkmcnt(0)
  v_mfma_f32_32x32x16_bf16 v[8:23], v[96:99], v[100:103], v[8:23]
  v_mfma_f32_32x32x16_bf16 v[24:39], v[96:99], v[104:107], v[24:39]
  s_barrier
  s_cmp_ge_u32 s24, 7
  s_cbranch_scc1 L_a4_dn_59
  s_add_u32 m0, s22, s71
  s_nop 0
  buffer_load_dwordx4 v47, s[28:31], s44 offen lds
  s_add_u32 m0, m0, 4096
  s_add_u32 s44, s44, 128
  buffer_load_dwordx4 v47, s[28:31], s45 offen lds
  s_add_u32 m0, s22, s72
  s_add_u32 s45, s45, 128
  buffer_load_dwordx4 v48, s[32:35], s46 offen lds
  s_add_u32 m0, m0, 8192
  s_nop 0
  buffer_load_dwordx4 v48, s[36:39], s46 offen lds
  s_add_u32 s46, s46, 128
  s_xor_b32 s22, s22, 32768
L_a4_dn_59:
  s_add_u32 s24, s24, 1
  s_cmp_lt_u32 s24, 9
  s_cbranch_scc1 L_a4_dl_57
L_a4_done_55:
  s_nop 15
  s_nop 3
  s_waitcnt vmcnt(0)
  v_lshlrev_b32 v44, 16, v44
  v_lshlrev_b32 v45, 16, v45
  v_lshlrev_b32 v46, 16, v46
  v_mul_f32 v46, 0x3fb8aa3b, v46
  v_exp_f32 v46, v46
  s_nop 0
  v_cvt_pk_bf16_f32 v46, v46, v46
  v_and_b32 v46, 0xffff0000, v46
  v_mul_f32 v48, v46, v44
  v_mul_f32 v49, v46, v45
  v_mul_f32 v48, 0x3fb8aa3b, v48
  v_exp_f32 v48, v48
  v_mul_f32 v49, 0.15915494, v49
  v_fract_f32 v49, v49
  v_cos_f32 v50, v49
  v_sin_f32 v49, v49
  s_nop 0
  v_mul_f32 v6, v48, v50
  v_mul_f32 v7, v48, v49
  v_mul_f32 v48, v6, v7
  v_mul_f32 v44, v6, v6
  v_fma_f32 v44, -v7, v7, v44
  v_add_f32 v45, v48, v48
  v_mul_f32 v48, v44, v45
  v_mul_f32 v44, v44, v44
  v_fma_f32 v44, -v45, v45, v44
  v_add_f32 v45, v48, v48
  v_mul_f32 v48, v44, v45
  v_mul_f32 v44, v44, v44
  v_fma_f32 v44, -v45, v45, v44
  v_add_f32 v45, v48, v48
  v_mul_f32 v48, v44, v45
  v_mul_f32 v44, v44, v44
  v_fma_f32 v44, -v45, v45, v44
  v_add_f32 v45, v48, v48
  v_mul_f32 v48, v44, v45
  v_mul_f32 v46, v44, v44
  v_fma_f32 v46, -v45, v45, v46
  v_add_f32 v54, v48, v48
  v_mul_f32 v48, v46, v54
  v_mul_f32 v55, v46, v46
  v_fma_f32 v55, -v54, v54, v55
  v_add_f32 v56, v48, v48
  v_mov_b32 v2, v8
  v_mov_b32 v3, v24
  v_fma_f32 v4, v6, v2, v9
  v_fma_f32 v5, v6, v3, v25
  v_fma_f32 v4, -v7, v3, v4
  v_fma_f32 v5, v7, v2, v5
  v_fma_f32 v2, v6, v4, v10
  v_fma_f32 v3, v6, v5, v26
  v_fma_f32 v2, -v7, v5, v2
  v_fma_f32 v3, v7, v4, v3
  v_fma_f32 v4, v6, v2, v11
  v_fma_f32 v5, v6, v3, v27
  v_fma_f32 v4, -v7, v3, v4
  v_fma_f32 v5, v7, v2, v5
  v_fma_f32 v2, v6, v4, v12
  v_fma_f32 v3, v6, v5, v28
  v_fma_f32 v2, -v7, v5, v2
  v_fma_f32 v3, v7, v4, v3
  v_fma_f32 v4, v6, v2, v13
  v_fma_f32 v5, v6, v3, v29
  v_fma_f32 v4, -v7, v3, v4
  v_fma_f32 v5, v7, v2, v5
  v_fma_f32 v2, v6, v4, v14
  v_fma_f32 v3, v6, v5, v30
  v_fma_f32 v2, -v7, v5, v2
  v_fma_f32 v3, v7, v4, v3
  v_fma_f32 v4, v6, v2, v15
  v_fma_f32 v5, v6, v3, v31
  v_fma_f32 v4, -v7, v3, v4
  v_fma_f32 v5, v7, v2, v5
  v_fma_f32 v2, v6, v4, v16
  v_fma_f32 v3, v6, v5, v32
  v_fma_f32 v2, -v7, v5, v2
  v_fma_f32 v3, v7, v4, v3
  v_fma_f32 v4, v6, v2, v17
  v_fma_f32 v5, v6, v3, v33
  v_fma_f32 v4, -v7, v3, v4
  v_fma_f32 v5, v7, v2, v5
  v_fma_f32 v2, v6, v4, v18
  v_fma_f32 v3, v6, v5, v34
  v_fma_f32 v2, -v7, v5, v2
  v_fma_f32 v3, v7, v4, v3
  v_fma_f32 v4, v6, v2, v19
  v_fma_f32 v5, v6, v3, v35
  v_fma_f32 v4, -v7, v3, v4
  v_fma_f32 v5, v7, v2, v5
  v_fma_f32 v2, v6, v4, v20
  v_fma_f32 v3, v6, v5, v36
  v_fma_f32 v2, -v7, v5, v2
  v_fma_f32 v3, v7, v4, v3
  v_fma_f32 v4, v6, v2, v21
  v_fma_f32 v5, v6, v3, v37
  v_fma_f32 v4, -v7, v3, v4
  v_fma_f32 v5, v7, v2, v5
  v_fma_f32 v2, v6, v4, v22
  v_fma_f32 v3, v6, v5, v38
  v_fma_f32 v2, -v7, v5, v2
  v_fma_f32 v3, v7, v4, v3
  v_fma_f32 v4, v6, v2, v23
  v_fma_f32 v5, v6, v3, v39
  v_fma_f32 v4, -v7, v3, v4
  v_fma_f32 v5, v7, v2, v5
  v_mov_b32 v2, v4
  v_mov_b32 v3, v5
  s_nop 1
  v_permlane32_swap_b32 v4, v2
  v_permlane32_swap_b32 v5, v3
  s_nop 1
  v_fma_f32 v60, v44, v4, v2
  v_fma_f32 v61, v44, v5, v3
  v_fma_f32 v60, -v45, v5, v60
  v_fma_f32 v61, v45, v4, v61
  v_and_b32 v48, 31, v1
  v_lshlrev_b32 v48, 3, v48
  s_lshl_b32 s69, s67, 8
  s_lshl_b32 s70, s19, 9
  s_add_u32 s69, s69, s70
  s_add_u32 s69, s69, 73728
  v_add_u32 v48, s69, v48
  s_cmp_eq_u32 s66, 0
  s_cbranch_scc0 L_a4_w1_60
  ds_write_b64 v48, v[60:61]
  s_waitcnt lgkmcnt(0)
L_a4_w1_60:
  s_barrier
  v_mov_b32 v58, 0
  v_mov_b32 v59, 0
  s_cmp_eq_u32 s66, 0
  s_cbranch_scc1 L_a4_w2_61
  ds_read_b64 v[58:59], v48
  s_waitcnt lgkmcnt(0)
  v_fma_f32 v52, v46, v58, v60
  v_fma_f32 v53, v46, v59, v61
  v_fma_f32 v52, -v54, v59, v52
  v_fma_f32 v53, v54, v58, v53
  s_mov_b32 exec_hi, 0
  buffer_store_dwordx2 v[52:53], v41, s[40:43], 0 offen sc1
  s_mov_b64 exec, -1
L_a4_w2_61:
  s_mov_b32 s74, 0
  v_subrev_u32 v51, 4608, v41
L_a4_pre_65:
  buffer_load_dword v52, v51, s[40:43], 0 offen sc1
  s_waitcnt vmcnt(0)
  v_cmp_eq_u32 vcc, -1, v52
  s_nop 1
  s_cbranch_vccz L_a4_poll_63
  s_sleep 4
  s_add_u32 s74, s74, 1
  s_cmp_lt_u32 s74, 100000
  s_cbranch_scc1 L_a4_pre_65
L_a4_poll_63:
  v_subrev_u32 v51, 142848, v41
  buffer_load_dwordx2 v[64:65], v51, s[40:43], 0 offen sc1
  v_add_u32 v51, 4608, v51
  buffer_load_dwordx2 v[66:67], v51, s[40:43], 0 offen sc1
  v_add_u32 v51, 4608, v51
  buffer_load_dwordx2 v[68:69], v51, s[40:43], 0 offen sc1
  v_add_u32 v51, 4608, v51
  buffer_load_dwordx2 v[70:71], v51, s[40:43], 0 offen sc1
  v_add_u32 v51, 4608, v51
  buffer_load_dwordx2 v[72:73], v51, s[40:43], 0 offen sc1
  v_add_u32 v51, 4608, v51
  buffer_load_dwordx2 v[74:75], v51, s[40:43], 0 offen sc1
  v_add_u32 v51, 4608, v51
  buffer_load_dwordx2 v[76:77], v51, s[40:43], 0 offen sc1
  v_add_u32 v51, 4608, v51
  buffer_load_dwordx2 v[78:79], v51, s[40:43], 0 offen sc1
  v_add_u32 v51, 4608, v51
  buffer_load_dwordx2 v[80:81], v51, s[40:43], 0 offen sc1
  v_add_u32 v51, 4608, v51
  buffer_load_dwordx2 v[82:83], v51, s[40:43], 0 offen sc1
  v_add_u32 v51, 4608, v51
  buffer_load_dwordx2 v[84:85], v51, s[40:43], 0 offen sc1
  v_add_u32 v51, 4608, v51
  buffer_load_dwordx2 v[86:87], v51, s[40:43], 0 offen sc1
  v_add_u32 v51, 4608, v51
  buffer_load_dwordx2 v[88:89], v51, s[40:43], 0 offen sc1
  v_add_u32 v51, 4608, v51
  buffer_load_dwordx2 v[90:91], v51, s[40:43], 0 offen sc1
  v_add_u32 v51, 4608, v51
  buffer_load_dwordx2 v[92:93], v51, s[40:43], 0 offen sc1
  v_add_u32 v51, 4608, v51
  buffer_load_dwordx2 v[94:95], v51, s[40:43], 0 offen sc1
  v_add_u32 v51, 4608, v51
  buffer_load_dwordx2 v[96:97], v51, s[40:43], 0 offen sc1
  v_add_u32 v51, 4608, v51
  buffer_load_dwordx2 v[98:99], v51, s[40:43], 0 offen sc1
  v_add_u32 v51, 4608, v51
  buffer_load_dwordx2 v[100:101], v51, s[40:43], 0 offen sc1
  v_add_u32 v51, 4608, v51
  buffer_load_dwordx2 v[102:103], v51, s[40:43], 0 offen sc1
  v_add_u32 v51, 4608, v51
  buffer_load_dwordx2 v[104:105], v51, s[40:43], 0 offen sc1
  v_add_u32 v51, 4608, v51
  buffer_load_dwordx2 v[106:107], v51, s[40:43], 0 offen sc1
  v_add_u32 v51, 4608, v51
  buffer_load_dwordx2 v[108:109], v51, s[40:43], 0 offen sc1
  v_add_u32 v51, 4608, v51
  buffer_load_dwordx2 v[110:111], v51, s[40:43], 0 offen sc1
  v_add_u32 v51, 4608, v51
  buffer_load_dwordx2 v[112:113], v51, s[40:43], 0 offen sc1
  v_add_u32 v51, 4608, v51
  buffer_load_dwordx2 v[114:115], v51, s[40:43], 0 offen sc1
  v_add_u32 v51, 4608, v51
  buffer_load_dwordx2 v[116:117], v51, s[40:43], 0 offen sc1
  v_add_u32 v51, 4608, v51
  buffer_load_dwordx2 v[118:119], v51, s[40:43], 0 offen sc1
  v_add_u32 v51, 4608, v51
  buffer_load_dwordx2 v[120:121], v51, s[40:43], 0 offen sc1
  v_add_u32 v51, 4608, v51
  buffer_load_dwordx2 v[122:123], v51, s[40:43], 0 offen sc1
  v_add_u32 v51, 4608, v51
  buffer_load_dwordx2 v[124:125], v51, s[40:43], 0 offen sc1
  v_add_u32 v51, 4608, v51
  s_waitcnt vmcnt(0)
  v_max_u32 v52, v64, v65
  v_max3_u32 v52, v52, v66, v67
  v_max3_u32 v52, v52, v68, v69
  v_max3_u32 v52, v52, v70, v71
  v_max3_u32 v52, v52, v72, v73
  v_max3_u32 v52, v52, v74, v75
  v_max3_u32 v52, v52, v76, v77
  v_max3_u32 v52, v52, v78, v79
  v_max3_u32 v52, v52, v80, v81
  v_max3_u32 v52, v52, v82, v83
  v_max3_u32 v52, v52, v84, v85
  v_max3_u32 v52, v52, v86, v87
  v_max3_u32 v52, v52, v88, v89
  v_max3_u32 v52, v52, v90, v91
  v_max3_u32 v52, v52, v92, v93
  v_max3_u32 v52, v52, v94, v95
  v_max3_u32 v52, v52, v96, v97
  v_max3_u32 v52, v52, v98, v99
  v_max3_u32 v52, v52, v100, v101
  v_max3_u32 v52, v52, v102, v103
  v_max3_u32 v52, v52, v104, v105
  v_max3_u32 v52, v52, v106, v107
  v_max3_u32 v52, v52, v108, v109
  v_max3_u32 v52, v52, v110, v111
  v_max3_u32 v52, v52, v112, v113
  v_max3_u32 v52, v52, v114, v115
  v_max3_u32 v52, v52, v116, v117
  v_max3_u32 v52, v52, v118, v119
  v_max3_u32 v52, v52, v120, v121
  v_max3_u32 v52, v52, v122, v123
  v_max3_u32 v52, v52, v124, v125
  v_cmp_eq_u32 vcc, -1, v52
  s_nop 1
  s_cbranch_vccz L_a4_ok_64
  s_sleep 8
  s_add_u32 s74, s74, 1
  s_cmp_lt_u32 s74, 100000
  s_cbranch_scc1 L_a4_poll_63
L_a4_ok_64:
  v_mov_b32 v2, v64
  v_mov_b32 v3, v65
  v_fma_f32 v48, v55, v2, v66
  v_fma_f32 v49, v55, v3, v67
  v_fma_f32 v48, -v56, v3, v48
  v_fma_f32 v49, v56, v2, v49
  v_fma_f32 v2, v55, v48, v68
  v_fma_f32 v3, v55, v49, v69
  v_fma_f32 v2, -v56, v49, v2
  v_fma_f32 v3, v56, v48, v3
  v_fma_f32 v48, v55, v2, v70
  v_fma_f32 v49, v55, v3, v71
  v_fma_f32 v48, -v56, v3, v48
  v_fma_f32 v49, v56, v2, v49
  v_fma_f32 v2, v55, v48, v72
  v_fma_f32 v3, v55, v49, v73
  v_fma_f32 v2, -v56, v49, v2
  v_fma_f32 v3, v56, v48, v3
  v_fma_f32 v48, v55, v2, v74
  v_fma_f32 v49, v55, v3, v75
  v_fma_f32 v48, -v56, v3, v48
  v_fma_f32 v49, v56, v2, v49
  v_fma_f32 v2, v55, v48, v76
  v_fma_f32 v3, v55, v49, v77
  v_fma_f32 v2, -v56, v49, v2
  v_fma_f32 v3, v56, v48, v3
  v_fma_f32 v48, v55, v2, v78
  v_fma_f32 v49, v55, v3, v79
  v_fma_f32 v48, -v56, v3, v48
  v_fma_f32 v49, v56, v2, v49
  v_fma_f32 v2, v55, v48, v80
  v_fma_f32 v3, v55, v49, v81
  v_fma_f32 v2, -v56, v49, v2
  v_fma_f32 v3, v56, v48, v3
  v_fma_f32 v48, v55, v2, v82
  v_fma_f32 v49, v55, v3, v83
  v_fma_f32 v48, -v56, v3, v48
  v_fma_f32 v49, v56, v2, v49
  v_fma_f32 v2, v55, v48, v84
  v_fma_f32 v3, v55, v49, v85
  v_fma_f32 v2, -v56, v49, v2
  v_fma_f32 v3, v56, v48, v3
  v_fma_f32 v48, v55, v2, v86
  v_fma_f32 v49, v55, v3, v87
  v_fma_f32 v48, -v56, v3, v48
  v_fma_f32 v49, v56, v2, v49
  v_fma_f32 v2, v55, v48, v88
  v_fma_f32 v3, v55, v49, v89
  v_fma_f32 v2, -v56, v49, v2
  v_fma_f32 v3, v56, v48, v3
  v_fma_f32 v48, v55, v2, v90
  v_fma_f32 v49, v55, v3, v91
  v_fma_f32 v48, -v56, v3, v48
  v_fma_f32 v49, v56, v2, v49
  v_fma_f32 v2, v55, v48, v92
  v_fma_f32 v3, v55, v49, v93
  v_fma_f32 v2, -v56, v49, v2
  v_fma_f32 v3, v56, v48, v3
  v_fma_f32 v48, v55, v2, v94
  v_fma_f32 v49, v55, v3, v95
  v_fma_f32 v48, -v56, v3, v48
  v_fma_f32 v49, v56, v2, v49
  v_fma_f32 v2, v55, v48, v96
  v_fma_f32 v3, v55, v49, v97
  v_fma_f32 v2, -v56, v49, v2
  v_fma_f32 v3, v56, v48, v3
  v_fma_f32 v48, v55, v2, v98
  v_fma_f32 v49, v55, v3, v99
  v_fma_f32 v48, -v56, v3, v48
  v_fma_f32 v49, v56, v2, v49
  v_fma_f32 v2, v55, v48, v100
  v_fma_f32 v3, v55, v49, v101
  v_fma_f32 v2, -v56, v49, v2
  v_fma_f32 v3, v56, v48, v3
  v_fma_f32 v48, v55, v2, v102
  v_fma_f32 v49, v55, v3, v103
  v_fma_f32 v48, -v56, v3, v48
  v_fma_f32 v49, v56, v2, v49
  v_fma_f32 v2, v55, v48, v104
  v_fma_f32 v3, v55, v49, v105
  v_fma_f32 v2, -v56, v49, v2
  v_fma_f32 v3, v56, v48, v3
  v_fma_f32 v48, v55, v2, v106
  v_fma_f32 v49, v55, v3, v107
  v_fma_f32 v48, -v56, v3, v48
  v_fma_f32 v49, v56, v2, v49
  v_fma_f32 v2, v55, v48, v108
  v_fma_f32 v3, v55, v49, v109
  v_fma_f32 v2, -v56, v49, v2
  v_fma_f32 v3, v56, v48, v3
  v_fma_f32 v48, v55, v2, v110
  v_fma_f32 v49, v55, v3, v111
  v_fma_f32 v48, -v56, v3, v48
  v_fma_f32 v49, v56, v2, v49
  v_fma_f32 v2, v55, v48, v112
  v_fma_f32 v3, v55, v49, v113
  v_fma_f32 v2, -v56, v49, v2
  v_fma_f32 v3, v56, v48, v3
  v_fma_f32 v48, v55, v2, v114
  v_fma_f32 v49, v55, v3, v115
  v_fma_f32 v48, -v56, v3, v48
  v_fma_f32 v49, v56, v2, v49
  v_fma_f32 v2, v55, v48, v116
  v_fma_f32 v3, v55, v49, v117
  v_fma_f32 v2, -v56, v49, v2
  v_fma_f32 v3, v56, v48, v3
  v_fma_f32 v48, v55, v2, v118
  v_fma_f32 v49, v55, v3, v119
  v_fma_f32 v48, -v56, v3, v48
  v_fma_f32 v49, v56, v2, v49
  v_fma_f32 v2, v55, v48, v120
  v_fma_f32 v3, v55, v49, v121
  v_fma_f32 v2, -v56, v49, v2
  v_fma_f32 v3, v56, v48, v3
  v_fma_f32 v48, v55, v2, v122
  v_fma_f32 v49, v55, v3, v123
  v_fma_f32 v48, -v56, v3, v48
  v_fma_f32 v49, v56, v2, v49
  v_fma_f32 v2, v55, v48, v124
  v_fma_f32 v3, v55, v49, v125
  v_fma_f32 v2, -v56, v49, v2
  v_fma_f32 v3, v56, v48, v3
  s_cmp_eq_u32 s66, 0
  s_cbranch_scc1 L_a4_s_66
  v_fma_f32 v48, v46, v2, v58
  v_fma_f32 v49, v46, v3, v59
  v_fma_f32 v48, -v54, v3, v48
  v_fma_f32 v49, v54, v2, v49
  v_mov_b32 v2, v48
  v_mov_b32 v3, v49
L_a4_s_66:
  v_cmp_gt_u32 vcc, 32, v1
  v_fma_f32 v48, v44, v2, v4
  v_fma_f32 v49, v44, v3, v5
  v_fma_f32 v48, -v45, v3, v48
  v_fma_f32 v49, v45, v2, v49
  v_cndmask_b32 v2, v48, v2, vcc
  v_cndmask_b32 v3, v49, v3, vcc
  v_and_b32 v50, 31, v1
  v_lshrrev_b32 v51, 4, v50
  v_lshlrev_b32 v51, 11, v51
  v_and_b32 v52, 3, v50
  v_lshlrev_b32 v52, 2, v52
  v_add_u32 v51, v51, v52
  v_lshrrev_b32 v52, 5, v1
  v_lshlrev_b32 v52, 10, v52
  v_add_u32 v51, v51, v52
  s_lshl_b32 s69, s20, 12
  s_lshl_b32 s70, s19, 14
  s_add_u32 s69, s69, s70
  v_add_u32 v51, s69, v51
  v_lshrrev_b32 v50, 2, v50
  v_and_b32 v50, 3, v50
  v_xor_b32 v52, 0, v50
  v_lshlrev_b32 v52, 4, v52
  v_add_u32 v64, v51, v52
  v_xor_b32 v52, 1, v50
  v_lshlrev_b32 v52, 4, v52
  v_add_u32 v65, v51, v52
  v_xor_b32 v52, 2, v50
  v_lshlrev_b32 v52, 4, v52
  v_add_u32 v66, v51, v52
  v_xor_b32 v52, 3, v50
  v_lshlrev_b32 v52, 4, v52
  v_add_u32 v67, v51, v52
  v_fma_f32 v8, v6, v2, v8
  v_fma_f32 v24, v6, v3, v24
  v_fma_f32 v8, -v7, v3, v8
  v_fma_f32 v24, v7, v2, v24
  v_cvt_pk_bf16_f32 v68, v8, v24
  ds_write_b32 v64, v68 offset:0
  v_fma_f32 v9, v6, v8, v9
  v_fma_f32 v25, v6, v24, v25
  v_fma_f32 v9, -v7, v24, v9
  v_fma_f32 v25, v7, v8, v25
  v_cvt_pk_bf16_f32 v69, v9, v25
  ds_write_b32 v64, v69 offset:64
  v_fma_f32 v10, v6, v9, v10
  v_fma_f32 v26, v6, v25, v26
  v_fma_f32 v10, -v7, v25, v10
  v_fma_f32 v26, v7, v9, v26
  v_cvt_pk_bf16_f32 v70, v10, v26
  ds_write_b32 v64, v70 offset:128
  v_fma_f32 v11, v6, v10, v11
  v_fma_f32 v27, v6, v26, v27
  v_fma_f32 v11, -v7, v26, v11
  v_fma_f32 v27, v7, v10, v27
  v_cvt_pk_bf16_f32 v71, v11, v27
  ds_write_b32 v64, v71 offset:192
  v_fma_f32 v12, v6, v11, v12
  v_fma_f32 v28, v6, v27, v28
  v_fma_f32 v12, -v7, v27, v12
  v_fma_f32 v28, v7, v11, v28
  v_cvt_pk_bf16_f32 v72, v12, v28
  ds_write_b32 v65, v72 offset:256
  v_fma_f32 v13, v6, v12, v13
  v_fma_f32 v29, v6, v28, v29
  v_fma_f32 v13, -v7, v28, v13
  v_fma_f32 v29, v7, v12, v29
  v_cvt_pk_bf16_f32 v73, v13, v29
  ds_write_b32 v65, v73 offset:320
  v_fma_f32 v14, v6, v13, v14
  v_fma_f32 v30, v6, v29, v30
  v_fma_f32 v14, -v7, v29, v14
  v_fma_f32 v30, v7, v13, v30
  v_cvt_pk_bf16_f32 v74, v14, v30
  ds_write_b32 v65, v74 offset:384
  v_fma_f32 v15, v6, v14, v15
  v_fma_f32 v31, v6, v30, v31
  v_fma_f32 v15, -v7, v30, v15
  v_fma_f32 v31, v7, v14, v31
  v_cvt_pk_bf16_f32 v75, v15, v31
  ds_write_b32 v65, v75 offset:448
  v_fma_f32 v16, v6, v15, v16
  v_fma_f32 v32, v6, v31, v32
  v_fma_f32 v16, -v7, v31, v16
  v_fma_f32 v32, v7, v15, v32
  v_cvt_pk_bf16_f32 v76, v16, v32
  ds_write_b32 v66, v76 offset:512
  v_fma_f32 v17, v6, v16, v17
  v_fma_f32 v33, v6, v32, v33
  v_fma_f32 v17, -v7, v32, v17
  v_fma_f32 v33, v7, v16, v33
  v_cvt_pk_bf16_f32 v77, v17, v33
  ds_write_b32 v66, v77 offset:576
  v_fma_f32 v18, v6, v17, v18
  v_fma_f32 v34, v6, v33, v34
  v_fma_f32 v18, -v7, v33, v18
  v_fma_f32 v34, v7, v17, v34
  v_cvt_pk_bf16_f32 v78, v18, v34
  ds_write_b32 v66, v78 offset:640
  v_fma_f32 v19, v6, v18, v19
  v_fma_f32 v35, v6, v34, v35
  v_fma_f32 v19, -v7, v34, v19
  v_fma_f32 v35, v7, v18, v35
  v_cvt_pk_bf16_f32 v79, v19, v35
  ds_write_b32 v66, v79 offset:704
  v_fma_f32 v20, v6, v19, v20
  v_fma_f32 v36, v6, v35, v36
  v_fma_f32 v20, -v7, v35, v20
  v_fma_f32 v36, v7, v19, v36
  v_cvt_pk_bf16_f32 v80, v20, v36
  ds_write_b32 v67, v80 offset:768
  v_fma_f32 v21, v6, v20, v21
  v_fma_f32 v37, v6, v36, v37
  v_fma_f32 v21, -v7, v36, v21
  v_fma_f32 v37, v7, v20, v37
  v_cvt_pk_bf16_f32 v81, v21, v37
  ds_write_b32 v67, v81 offset:832
  v_fma_f32 v22, v6, v21, v22
  v_fma_f32 v38, v6, v37, v38
  v_fma_f32 v22, -v7, v37, v22
  v_fma_f32 v38, v7, v21, v38
  v_cvt_pk_bf16_f32 v82, v22, v38
  ds_write_b32 v67, v82 offset:896
  v_fma_f32 v23, v6, v22, v23
  v_fma_f32 v39, v6, v38, v39
  v_fma_f32 v23, -v7, v38, v23
  v_fma_f32 v39, v7, v22, v39
  v_cvt_pk_bf16_f32 v83, v23, v39
  ds_write_b32 v67, v83 offset:960
  s_mov_b32 s28, s62
  s_and_b32 s29, s63, 0xffff
  s_mov_b32 s30, 20262912
  s_mov_b32 s31, 0x20000
  s_lshr_b32 s45, s26, 1
  s_mul_i32 s45, s45, 36
  s_lshr_b32 s47, s68, 4
  s_add_u32 s45, s45, s47
  s_lshl_b32 s45, s45, 13
  s_and_b32 s47, s26, 1
  s_lshl_b32 s47, s47, 12
  s_add_u32 s45, s45, s47
  s_lshl_b32 s47, s66, 11
  s_add_u32 s45, s45, s47
  s_add_u32 s45, s45, 11694080
  s_add_u32 s47, s45, 8192
  v_lshlrev_b32 v50, 4, v1
  v_add_u32 v51, s69, v50
  s_waitcnt lgkmcnt(0)
  ds_read_b128 v[88:91], v51
  ds_read_b128 v[92:95], v51 offset:1024
  ds_read_b128 v[96:99], v51 offset:2048
  ds_read_b128 v[100:103], v51 offset:3072
  s_waitcnt lgkmcnt(0)
  buffer_store_dwordx4 v[88:91], v50, s[28:31], s45 offen sc1
  buffer_store_dwordx4 v[92:95], v50, s[28:31], s45 offen offset:1024 sc1
  buffer_store_dwordx4 v[96:99], v50, s[28:31], s47 offen sc1
  buffer_store_dwordx4 v[100:103], v50, s[28:31], s47 offen offset:1024 sc1
  s_lshr_b32 s69, s26, 1
  s_lshl_b32 s69, s69, 8
  s_add_u32 s69, s69, 20254720
  v_mov_b32 v51, s69
  v_mov_b32 v52, 1
  s_waitcnt vmcnt(0)
  s_mov_b64 exec, 1
  global_atomic_add v51, v52, s[62:63]
  s_mov_b64 exec, -1
  s_branch L_a4_exit_48
L_a4_loader_47:
  s_mov_b32 s22, 0
  s_add_u32 m0, s22, s58
  s_nop 0
  buffer_load_dwordx4 v47, s[28:31], s44 offen lds
  s_add_u32 m0, m0, 4096
  s_add_u32 s44, s44, 128
  buffer_load_dwordx4 v47, s[28:31], s45 offen lds
  s_add_u32 m0, m0, 4096
  s_add_u32 s45, s45, 128
  buffer_load_dwordx4 v48, s[32:35], s46 offen lds
  s_add_u32 m0, m0, 4096
  s_add_u32 s47, s46, 36864
  buffer_load_dwordx4 v48, s[32:35], s47 offen lds
  s_add_u32 m0, m0, 4096
  s_nop 0
  buffer_load_dwordx4 v48, s[36:39], s46 offen lds
  s_add_u32 m0, m0, 4096
  s_add_u32 s46, s46, 128
  buffer_load_dwordx4 v48, s[36:39], s47 offen lds
  s_add_u32 s22, s22, 24576
  s_cmp_ge_u32 s22, 73728
  s_cselect_b32 s22, 0, s22
  s_add_u32 m0, s22, s58
  s_nop 0
  buffer_load_dwordx4 v47, s[28:31], s44 offen lds
  s_add_u32 m0, m0, 4096
  s_add_u32 s44, s44, 128
  buffer_load_dwordx4 v47, s[28:31], s45 offen lds
  s_add_u32 m0, m0, 4096
  s_add_u32 s45, s45, 128
  buffer_load_dwordx4 v48, s[32:35], s46 offen lds
  s_add_u32 m0, m0, 4096
  s_add_u32 s47, s46, 36864
  buffer_load_dwordx4 v48, s[32:35], s47 offen lds
  s_add_u32 m0, m0, 4096
  s_nop 0
  buffer_load_dwordx4 v48, s[36:39], s46 offen lds
  s_add_u32 m0, m0, 4096
  s_add_u32 s46, s46, 128
  buffer_load_dwordx4 v48, s[36:39], s47 offen lds
  s_add_u32 s22, s22, 24576
  s_cmp_ge_u32 s22, 73728
  s_cselect_b32 s22, 0, s22
  s_mov_b32 s24, 0
L_a4_ll_67:
  s_cmp_ge_u32 s24, 8
  s_cbranch_scc0 L_a4_lw_68
  s_waitcnt vmcnt(0)
L_a4_lw_68:
  s_waitcnt vmcnt(6)
  s_barrier
  s_cmp_ge_u32 s24, 7
  s_cbranch_scc1 L_a4_ln_69
  s_add_u32 m0, s22, s58
  s_nop 0
  buffer_load_dwordx4 v47, s[28:31], s44 offen lds
  s_add_u32 m0, m0, 4096
  s_add_u32 s44, s44, 128
  buffer_load_dwordx4 v47, s[28:31], s45 offen lds
  s_add_u32 m0, m0, 4096
  s_add_u32 s45, s45, 128
  buffer_load_dwordx4 v48, s[32:35], s46 offen lds
  s_add_u32 m0, m0, 4096
  s_add_u32 s47, s46, 36864
  buffer_load_dwordx4 v48, s[32:35], s47 offen lds
  s_add_u32 m0, m0, 4096
  s_nop 0
  buffer_load_dwordx4 v48, s[36:39], s46 offen lds
  s_add_u32 m0, m0, 4096
  s_add_u32 s46, s46, 128
  buffer_load_dwordx4 v48, s[36:39], s47 offen lds
  s_add_u32 s22, s22, 24576
  s_cmp_ge_u32 s22, 73728
  s_cselect_b32 s22, 0, s22
L_a4_ln_69:
  s_add_u32 s24, s24, 1
  s_cmp_lt_u32 s24, 9
  s_cbranch_scc1 L_a4_ll_67
  s_barrier
L_a4_exit_48:
  s_branch L_k2_y
L_k2_y:
  s_lshr_b32 s5, s3, 3
  s_sub_u32 s5, s5, 4
  s_cmp_lt_u32 s5, 18
  s_cbranch_scc0 L_k2_o
  s_barrier
  s_cmp_ge_u32 s5, 9
  s_cselect_b32 s26, 8, 0
  s_cselect_b32 s27, 9, 0
  s_sub_u32 s27, s5, s27
  s_and_b32 s4, s3, 7
  s_add_u32 s26, s26, s4
  s_cmp_ge_u32 s26, 12
  s_cbranch_scc1 L_k2_yfast
  s_setprio 3
L_g2_top_70:
  s_load_dwordx2 s[4:5], s[0:1], 0
  s_load_dwordx2 s[6:7], s[0:1], 64
  s_load_dwordx2 s[8:9], s[0:1], 96
  s_load_dwordx4 s[60:63], s[0:1], 104
  v_and_b32 v1, 63, v0
  v_lshrrev_b32 v2, 6, v0
  s_nop 0
  v_readfirstlane_b32 s20, v2
  s_waitcnt lgkmcnt(0)
  s_cmp_ge_u32 s20, 4
  s_cbranch_scc1 L_g2_loader_71
  s_lshr_b32 s28, s20, 1
  s_and_b32 s29, s20, 1
  s_mov_b32 s32, s8
  s_and_b32 s33, s9, 0xffff
  s_mov_b32 s34, 9437184
  s_mov_b32 s35, 0x20000
  s_lshl_b32 s30, s27, 6
  s_lshl_b32 s31, s29, 5
  s_add_u32 s30, s30, s31
  v_and_b32 v2, 31, v1
  v_add_u32 v2, s30, v2
  v_lshrrev_b32 v3, 5, v1
  v_lshlrev_b32 v3, 2, v3
  s_lshl_b32 s31, s26, 7
  s_lshl_b32 s44, s28, 6
  s_add_u32 s31, s31, s44
  v_add_u32 v3, s31, v3
  v_mul_u32_u24 v40, 4608, v3
  v_lshlrev_b32 v4, 2, v2
  v_add_u32 v40, v40, v4
  s_mov_b32 s36, s4
  s_and_b32 s37, s5, 0xffff
  s_mov_b32 s38, 2359296
  s_mov_b32 s39, 0x20000
  s_mov_b32 s40, s6
  s_and_b32 s41, s7, 0xffff
  s_mov_b32 s42, 1152
  s_mov_b32 s43, 0x20000
  v_mul_u32_u24 v41, 1152, v3
  v_lshlrev_b32 v4, 1, v2
  v_add_u32 v41, v41, v4
  buffer_load_ushort v42, v4, s[40:43], 0 offen
  s_mov_b32 s45, 0
  buffer_load_ushort v44, v41, s[36:39], s45 offen
  s_mov_b32 s45, 1152
  buffer_load_ushort v45, v41, s[36:39], s45 offen
  s_mov_b32 s45, 2304
  buffer_load_ushort v46, v41, s[36:39], s45 offen
  s_mov_b32 s45, 3456
  buffer_load_ushort v47, v41, s[36:39], s45 offen
  s_mov_b32 s45, 9216
  buffer_load_ushort v48, v41, s[36:39], s45 offen
  s_mov_b32 s45, 10368
  buffer_load_ushort v49, v41, s[36:39], s45 offen
  s_mov_b32 s45, 11520
  buffer_load_ushort v50, v41, s[36:39], s45 offen
  s_mov_b32 s45, 12672
  buffer_load_ushort v51, v41, s[36:39], s45 offen
  s_mov_b32 s45, 18432
  buffer_load_ushort v52, v41, s[36:39], s45 offen
  s_mov_b32 s45, 19584
  buffer_load_ushort v53, v41, s[36:39], s45 offen
  s_mov_b32 s45, 20736
  buffer_load_ushort v54, v41, s[36:39], s45 offen
  s_mov_b32 s45, 21888
  buffer_load_ushort v55, v41, s[36:39], s45 offen
  s_mov_b32 s45, 27648
  buffer_load_ushort v56, v41, s[36:39], s45 offen
  s_mov_b32 s45, 28800
  buffer_load_ushort v57, v41, s[36:39], s45 offen
  s_mov_b32 s45, 29952
  buffer_load_ushort v58, v41, s[36:39], s45 offen
  s_mov_b32 s45, 31104
  buffer_load_ushort v59, v41, s[36:39], s45 offen
  s_mov_b32 s45, 36864
  buffer_load_ushort v60, v41, s[36:39], s45 offen
  s_mov_b32 s45, 38016
  buffer_load_ushort v61, v41, s[36:39], s45 offen
  s_mov_b32 s45, 39168
  buffer_load_ushort v62, v41, s[36:39], s45 offen
  s_mov_b32 s45, 40320
  buffer_load_ushort v63, v41, s[36:39], s45 offen
  s_mov_b32 s45, 46080
  buffer_load_ushort v64, v41, s[36:39], s45 offen
  s_mov_b32 s45, 47232
  buffer_load_ushort v65, v41, s[36:39], s45 offen
  s_mov_b32 s45, 48384
  buffer_load_ushort v66, v41, s[36:39], s45 offen
  s_mov_b32 s45, 49536
  buffer_load_ushort v67, v41, s[36:39], s45 offen
  s_mov_b32 s45, 55296
  buffer_load_ushort v68, v41, s[36:39], s45 offen
  s_mov_b32 s45, 56448
  buffer_load_ushort v69, v41, s[36:39], s45 offen
  s_mov_b32 s45, 57600
  buffer_load_ushort v70, v41, s[36:39], s45 offen
  s_mov_b32 s45, 58752
  buffer_load_ushort v71, v41, s[36:39], s45 offen
  s_mov_b32 s45, 64512
  buffer_load_ushort v72, v41, s[36:39], s45 offen
  s_mov_b32 s45, 65664
  buffer_load_ushort v73, v41, s[36:39], s45 offen
  s_mov_b32 s45, 66816
  buffer_load_ushort v74, v41, s[36:39], s45 offen
  s_mov_b32 s45, 67968
  buffer_load_ushort v75, v41, s[36:39], s45 offen
  v_mov_b32 v8, 0
  v_mov_b32 v9, 0
  v_mov_b32 v10, 0
  v_mov_b32 v11, 0
  v_mov_b32 v12, 0
  v_mov_b32 v13, 0
  v_mov_b32 v14, 0
  v_mov_b32 v15, 0
  v_mov_b32 v16, 0
  v_mov_b32 v17, 0
  v_mov_b32 v18, 0
  v_mov_b32 v19, 0
  v_mov_b32 v20, 0
  v_mov_b32 v21, 0
  v_mov_b32 v22, 0
  v_mov_b32 v23, 0
  v_mov_b32 v24, 0
  v_mov_b32 v25, 0
  v_mov_b32 v26, 0
  v_mov_b32 v27, 0
  v_mov_b32 v28, 0
  v_mov_b32 v29, 0
  v_mov_b32 v30, 0
  v_mov_b32 v31, 0
  v_mov_b32 v32, 0
  v_mov_b32 v33, 0
  v_mov_b32 v34, 0
  v_mov_b32 v35, 0
  v_mov_b32 v36, 0
  v_mov_b32 v37, 0
  v_mov_b32 v38, 0
  v_mov_b32 v39, 0
  s_lshl_b32 s28, s28, 12
  s_lshl_b32 s29, s29, 11
  v_and_b32 v2, 31, v1
  v_lshrrev_b32 v3, 2, v2
  v_and_b32 v3, 3, v3
  v_lshrrev_b32 v4, 5, v1
  v_xor_b32 v3, v3, v4
  v_lshlrev_b32 v3, 4, v3
  v_lshlrev_b32 v2, 6, v2
  v_add_u32 v2, v2, v3
  v_add_u32 v76, s28, v2
  v_add_u32 v77, s29, v2
  v_add_u32 v77, 16384, v77
  s_mov_b32 s25, 0
  s_mov_b32 s24, 0
L_c_loop_73:
  v_add_u32 v78, s25, v76
  v_add_u32 v79, s25, v77
  v_xor_b32 v4, 32, v78
  v_xor_b32 v5, 32, v79
  s_add_u32 s25, s25, 24576
  s_cmp_ge_u32 s25, 73728
  s_cselect_b32 s25, 0, s25
  s_waitcnt lgkmcnt(0)
  s_barrier
  ds_read_b128 v[80:83], v78 offset:0
  ds_read_b128 v[84:87], v78 offset:2048
  ds_read_b128 v[88:91], v79 offset:0
  s_waitcnt lgkmcnt(0)
  v_mfma_f32_32x32x16_bf16 v[8:23], v[80:83], v[88:91], v[8:23]
  v_mfma_f32_32x32x16_bf16 v[24:39], v[84:87], v[88:91], v[24:39]
  ds_read_b128 v[80:83], v4 offset:0
  ds_read_b128 v[84:87], v4 offset:2048
  ds_read_b128 v[88:91], v5 offset:0
  s_waitcnt lgkmcnt(0)
  v_mfma_f32_32x32x16_bf16 v[8:23], v[80:83], v[88:91], v[8:23]
  v_mfma_f32_32x32x16_bf16 v[24:39], v[84:87], v[88:91], v[24:39]
  ds_read_b128 v[80:83], v78 offset:8192
  ds_read_b128 v[84:87], v78 offset:10240
  ds_read_b128 v[88:91], v79 offset:4096
  s_waitcnt lgkmcnt(0)
  v_mfma_f32_32x32x16_bf16 v[8:23], v[80:83], v[88:91], v[8:23]
  v_mfma_f32_32x32x16_bf16 v[24:39], v[84:87], v[88:91], v[24:39]
  ds_read_b128 v[80:83], v4 offset:8192
  ds_read_b128 v[84:87], v4 offset:10240
  ds_read_b128 v[88:91], v5 offset:4096
  s_waitcnt lgkmcnt(0)
  v_mfma_f32_32x32x16_bf16 v[8:23], v[80:83], v[88:91], v[8:23]
  v_mfma_f32_32x32x16_bf16 v[24:39], v[84:87], v[88:91], v[24:39]
  s_add_u32 s24, s24, 1
  s_cmp_lt_u32 s24, 17
  s_cbranch_scc1 L_c_loop_73
  v_add_u32 v78, s25, v76
  v_add_u32 v79, s25, v77
  v_xor_b32 v4, 32, v78
  v_xor_b32 v5, 32, v79
  s_add_u32 s25, s25, 24576
  s_cmp_ge_u32 s25, 73728
  s_cselect_b32 s25, 0, s25
  s_waitcnt lgkmcnt(0)
  s_barrier
  ds_read_b128 v[80:83], v78 offset:0
  ds_read_b128 v[84:87], v78 offset:2048
  ds_read_b128 v[88:91], v79 offset:0
  s_waitcnt lgkmcnt(0)
  v_mfma_f32_32x32x16_bf16 v[8:23], v[80:83], v[88:91], v[8:23]
  v_mfma_f32_32x32x16_bf16 v[24:39], v[84:87], v[88:91], v[24:39]
  ds_read_b128 v[80:83], v4 offset:0
  ds_read_b128 v[84:87], v4 offset:2048
  ds_read_b128 v[88:91], v5 offset:0
  s_waitcnt lgkmcnt(0)
  v_mfma_f32_32x32x16_bf16 v[8:23], v[80:83], v[88:91], v[8:23]
  v_mfma_f32_32x32x16_bf16 v[24:39], v[84:87], v[88:91], v[24:39]
  ds_read_b128 v[80:83], v78 offset:8192
  ds_read_b128 v[84:87], v78 offset:10240
  ds_read_b128 v[88:91], v79 offset:4096
  s_waitcnt lgkmcnt(0)
  v_mfma_f32_32x32x16_bf16 v[8:23], v[80:83], v[88:91], v[8:23]
  v_mfma_f32_32x32x16_bf16 v[24:39], v[84:87], v[88:91], v[24:39]
  ds_read_b128 v[80:83], v4 offset:8192
  ds_read_b128 v[84:87], v4 offset:10240
  ds_read_b128 v[88:91], v5 offset:4096
  s_waitcnt lgkmcnt(0)
  v_mfma_f32_32x32x16_bf16 v[8:23], v[80:83], v[88:91], v[8:23]
  v_mfma_f32_32x32x16_bf16 v[24:39], v[84:87], v[88:91], v[24:39]
  s_nop 15
  s_nop 3
  s_waitcnt vmcnt(0)
  v_lshlrev_b32 v42, 16, v42
  v_lshlrev_b32 v44, 16, v44
  v_fma_f32 v8, v44, v42, v8
  s_mov_b32 s45, 0
  buffer_store_dword v8, v40, s[32:35], s45 offen sc1 nt
  v_lshlrev_b32 v45, 16, v45
  v_fma_f32 v9, v45, v42, v9
  s_mov_b32 s45, 4608
  buffer_store_dword v9, v40, s[32:35], s45 offen sc1 nt
  v_lshlrev_b32 v46, 16, v46
  v_fma_f32 v10, v46, v42, v10
  s_mov_b32 s45, 9216
  buffer_store_dword v10, v40, s[32:35], s45 offen sc1 nt
  v_lshlrev_b32 v47, 16, v47
  v_fma_f32 v11, v47, v42, v11
  s_mov_b32 s45, 13824
  buffer_store_dword v11, v40, s[32:35], s45 offen sc1 nt
  v_lshlrev_b32 v48, 16, v48
  v_fma_f32 v12, v48, v42, v12
  s_mov_b32 s45, 36864
  buffer_store_dword v12, v40, s[32:35], s45 offen sc1 nt
  v_lshlrev_b32 v49, 16, v49
  v_fma_f32 v13, v49, v42, v13
  s_mov_b32 s45, 41472
  buffer_store_dword v13, v40, s[32:35], s45 offen sc1 nt
  v_lshlrev_b32 v50, 16, v50
  v_fma_f32 v14, v50, v42, v14
  s_mov_b32 s45, 46080
  buffer_store_dword v14, v40, s[32:35], s45 offen sc1 nt
  v_lshlrev_b32 v51, 16, v51
  v_fma_f32 v15, v51, v42, v15
  s_mov_b32 s45, 50688
  buffer_store_dword v15, v40, s[32:35], s45 offen sc1 nt
  v_lshlrev_b32 v52, 16, v52
  v_fma_f32 v16, v52, v42, v16
  s_mov_b32 s45, 73728
  buffer_store_dword v16, v40, s[32:35], s45 offen sc1 nt
  v_lshlrev_b32 v53, 16, v53
  v_fma_f32 v17, v53, v42, v17
  s_mov_b32 s45, 78336
  buffer_store_dword v17, v40, s[32:35], s45 offen sc1 nt
  v_lshlrev_b32 v54, 16, v54
  v_fma_f32 v18, v54, v42, v18
  s_mov_b32 s45, 82944
  buffer_store_dword v18, v40, s[32:35], s45 offen sc1 nt
  v_lshlrev_b32 v55, 16, v55
  v_fma_f32 v19, v55, v42, v19
  s_mov_b32 s45, 87552
  buffer_store_dword v19, v40, s[32:35], s45 offen sc1 nt
  v_lshlrev_b32 v56, 16, v56
  v_fma_f32 v20, v56, v42, v20
  s_mov_b32 s45, 110592
  buffer_store_dword v20, v40, s[32:35], s45 offen sc1 nt
  v_lshlrev_b32 v57, 16, v57
  v_fma_f32 v21, v57, v42, v21
  s_mov_b32 s45, 115200
  buffer_store_dword v21, v40, s[32:35], s45 offen sc1 nt
  v_lshlrev_b32 v58, 16, v58
  v_fma_f32 v22, v58, v42, v22
  s_mov_b32 s45, 119808
  buffer_store_dword v22, v40, s[32:35], s45 offen sc1 nt
  v_lshlrev_b32 v59, 16, v59
  v_fma_f32 v23, v59, v42, v23
  s_mov_b32 s45, 124416
  buffer_store_dword v23, v40, s[32:35], s45 offen sc1 nt
  v_lshlrev_b32 v60, 16, v60
  v_fma_f32 v24, v60, v42, v24
  s_mov_b32 s45, 147456
  buffer_store_dword v24, v40, s[32:35], s45 offen sc1 nt
  v_lshlrev_b32 v61, 16, v61
  v_fma_f32 v25, v61, v42, v25
  s_mov_b32 s45, 152064
  buffer_store_dword v25, v40, s[32:35], s45 offen sc1 nt
  v_lshlrev_b32 v62, 16, v62
  v_fma_f32 v26, v62, v42, v26
  s_mov_b32 s45, 156672
  buffer_store_dword v26, v40, s[32:35], s45 offen sc1 nt
  v_lshlrev_b32 v63, 16, v63
  v_fma_f32 v27, v63, v42, v27
  s_mov_b32 s45, 161280
  buffer_store_dword v27, v40, s[32:35], s45 offen sc1 nt
  v_lshlrev_b32 v64, 16, v64
  v_fma_f32 v28, v64, v42, v28
  s_mov_b32 s45, 184320
  buffer_store_dword v28, v40, s[32:35], s45 offen sc1 nt
  v_lshlrev_b32 v65, 16, v65
  v_fma_f32 v29, v65, v42, v29
  s_mov_b32 s45, 188928
  buffer_store_dword v29, v40, s[32:35], s45 offen sc1 nt
  v_lshlrev_b32 v66, 16, v66
  v_fma_f32 v30, v66, v42, v30
  s_mov_b32 s45, 193536
  buffer_store_dword v30, v40, s[32:35], s45 offen sc1 nt
  v_lshlrev_b32 v67, 16, v67
  v_fma_f32 v31, v67, v42, v31
  s_mov_b32 s45, 198144
  buffer_store_dword v31, v40, s[32:35], s45 offen sc1 nt
  v_lshlrev_b32 v68, 16, v68
  v_fma_f32 v32, v68, v42, v32
  s_mov_b32 s45, 221184
  buffer_store_dword v32, v40, s[32:35], s45 offen sc1 nt
  v_lshlrev_b32 v69, 16, v69
  v_fma_f32 v33, v69, v42, v33
  s_mov_b32 s45, 225792
  buffer_store_dword v33, v40, s[32:35], s45 offen sc1 nt
  v_lshlrev_b32 v70, 16, v70
  v_fma_f32 v34, v70, v42, v34
  s_mov_b32 s45, 230400
  buffer_store_dword v34, v40, s[32:35], s45 offen sc1 nt
  v_lshlrev_b32 v71, 16, v71
  v_fma_f32 v35, v71, v42, v35
  s_mov_b32 s45, 235008
  buffer_store_dword v35, v40, s[32:35], s45 offen sc1 nt
  v_lshlrev_b32 v72, 16, v72
  v_fma_f32 v36, v72, v42, v36
  s_mov_b32 s45, 258048
  buffer_store_dword v36, v40, s[32:35], s45 offen sc1 nt
  v_lshlrev_b32 v73, 16, v73
  v_fma_f32 v37, v73, v42, v37
  s_mov_b32 s45, 262656
  buffer_store_dword v37, v40, s[32:35], s45 offen sc1 nt
  v_lshlrev_b32 v74, 16, v74
  v_fma_f32 v38, v74, v42, v38
  s_mov_b32 s45, 267264
  buffer_store_dword v38, v40, s[32:35], s45 offen sc1 nt
  v_lshlrev_b32 v75, 16, v75
  v_fma_f32 v39, v75, v42, v39
  s_mov_b32 s45, 271872
  buffer_store_dword v39, v40, s[32:35], s45 offen sc1 nt
  s_branch L_g2_exit_72
L_g2_loader_71:
  s_mov_b32 s28, s62
  s_and_b32 s29, s63, 0xffff
  s_mov_b32 s30, 20262912
  s_mov_b32 s31, 0x20000
  s_lshl_b32 s46, s26, 8
  s_add_u32 s46, s46, 20254720
  v_mov_b32 v5, s46
  s_mov_b32 s48, 0
L_g2_poll_74:
  global_load_dword v4, v5, s[62:63] sc1
  s_waitcnt vmcnt(0)
  v_readfirstlane_b32 s47, v4
  s_cmp_ge_u32 s47, 72
  s_cbranch_scc1 L_g2_poll_74_ok
  s_sleep 8
  s_add_u32 s48, s48, 1
  s_cmp_lt_u32 s48, 400000
  s_cbranch_scc1 L_g2_poll_74
L_g2_poll_74_ok:
  s_sub_u32 s21, s20, 4
  v_lshlrev_b32 v8, 4, v1
  s_lshl_b32 s46, s21, 10
  s_mul_i32 s44, s26, 294912
  s_add_u32 s44, s44, s46
  s_add_u32 s44, s44, 11694080
  s_mul_i32 s45, s27, 147456
  s_add_u32 s45, s45, s46
  s_add_u32 s45, s45, 10366976
  s_lshl_b32 s22, s21, 10
  s_add_u32 m0, s22, 0
  s_add_u32 s23, s44, 0
  buffer_load_dwordx4 v8, s[28:31], s23 offen lds
  s_add_u32 m0, s22, 4096
  s_add_u32 s23, s44, 4096
  buffer_load_dwordx4 v8, s[28:31], s23 offen lds
  s_add_u32 m0, s22, 8192
  s_add_u32 s23, s44, 8192
  buffer_load_dwordx4 v8, s[28:31], s23 offen lds
  s_add_u32 m0, s22, 12288
  s_add_u32 s23, s44, 12288
  buffer_load_dwordx4 v8, s[28:31], s23 offen lds
  s_add_u32 m0, s22, 16384
  s_add_u32 s23, s45, 0
  buffer_load_dwordx4 v8, s[28:31], s23 offen lds
  s_add_u32 m0, s22, 20480
  s_add_u32 s23, s45, 4096
  buffer_load_dwordx4 v8, s[28:31], s23 offen lds
  s_add_u32 s44, s44, 16384
  s_add_u32 s45, s45, 8192
  s_add_u32 s22, s22, 24576
  s_sub_u32 s23, s22, 73728
  s_cmp_ge_u32 s22, 73728
  s_cselect_b32 s22, s23, s22
  s_add_u32 m0, s22, 0
  s_add_u32 s23, s44, 0
  buffer_load_dwordx4 v8, s[28:31], s23 offen lds
  s_add_u32 m0, s22, 4096
  s_add_u32 s23, s44, 4096
  buffer_load_dwordx4 v8, s[28:31], s23 offen lds
  s_add_u32 m0, s22, 8192
  s_add_u32 s23, s44, 8192
  buffer_load_dwordx4 v8, s[28:31], s23 offen lds
  s_add_u32 m0, s22, 12288
  s_add_u32 s23, s44, 12288
  buffer_load_dwordx4 v8, s[28:31], s23 offen lds
  s_add_u32 m0, s22, 16384
  s_add_u32 s23, s45, 0
  buffer_load_dwordx4 v8, s[28:31], s23 offen lds
  s_add_u32 m0, s22, 20480
  s_add_u32 s23, s45, 4096
  buffer_load_dwordx4 v8, s[28:31], s23 offen lds
  s_add_u32 s44, s44, 16384
  s_add_u32 s45, s45, 8192
  s_add_u32 s22, s22, 24576
  s_sub_u32 s23, s22, 73728
  s_cmp_ge_u32 s22, 73728
  s_cselect_b32 s22, s23, s22
  s_waitcnt vmcnt(6)
  s_barrier
  s_add_u32 m0, s22, 0
  s_add_u32 s23, s44, 0
  buffer_load_dwordx4 v8, s[28:31], s23 offen lds
  s_add_u32 m0, s22, 4096
  s_add_u32 s23, s44, 4096
  buffer_load_dwordx4 v8, s[28:31], s23 offen lds
  s_add_u32 m0, s22, 8192
  s_add_u32 s23, s44, 8192
  buffer_load_dwordx4 v8, s[28:31], s23 offen lds
  s_add_u32 m0, s22, 12288
  s_add_u32 s23, s44, 12288
  buffer_load_dwordx4 v8, s[28:31], s23 offen lds
  s_add_u32 m0, s22, 16384
  s_add_u32 s23, s45, 0
  buffer_load_dwordx4 v8, s[28:31], s23 offen lds
  s_add_u32 m0, s22, 20480
  s_add_u32 s23, s45, 4096
  buffer_load_dwordx4 v8, s[28:31], s23 offen lds
  s_add_u32 s44, s44, 16384
  s_add_u32 s45, s45, 8192
  s_add_u32 s22, s22, 24576
  s_sub_u32 s23, s22, 73728
  s_cmp_ge_u32 s22, 73728
  s_cselect_b32 s22, s23, s22
  s_mov_b32 s24, 1
L_ld_loop_75:
  s_cmp_ge_u32 s24, 17
  s_cbranch_scc0 L_ld_w_77
  s_waitcnt vmcnt(0)
L_ld_w_77:
  s_waitcnt vmcnt(6)
  s_barrier
  s_cmp_ge_u32 s24, 16
  s_cbranch_scc1 L_ld_tail_76
  s_add_u32 m0, s22, 0
  s_add_u32 s23, s44, 0
  buffer_load_dwordx4 v8, s[28:31], s23 offen lds
  s_add_u32 m0, s22, 4096
  s_add_u32 s23, s44, 4096
  buffer_load_dwordx4 v8, s[28:31], s23 offen lds
  s_add_u32 m0, s22, 8192
  s_add_u32 s23, s44, 8192
  buffer_load_dwordx4 v8, s[28:31], s23 offen lds
  s_add_u32 m0, s22, 12288
  s_add_u32 s23, s44, 12288
  buffer_load_dwordx4 v8, s[28:31], s23 offen lds
  s_add_u32 m0, s22, 16384
  s_add_u32 s23, s45, 0
  buffer_load_dwordx4 v8, s[28:31], s23 offen lds
  s_add_u32 m0, s22, 20480
  s_add_u32 s23, s45, 4096
  buffer_load_dwordx4 v8, s[28:31], s23 offen lds
  s_add_u32 s44, s44, 16384
  s_add_u32 s45, s45, 8192
  s_add_u32 s22, s22, 24576
  s_sub_u32 s23, s22, 73728
  s_cmp_ge_u32 s22, 73728
  s_cselect_b32 s22, s23, s22
L_ld_tail_76:
  s_add_u32 s24, s24, 1
  s_cmp_lt_u32 s24, 18
  s_cbranch_scc1 L_ld_loop_75
  s_branch L_g2_exit_72
L_g2_exit_72:
  s_branch L_k2_o
L_k2_yfast:
  s_setprio 3
L_g2_top_78:
  s_load_dwordx2 s[4:5], s[0:1], 0
  s_load_dwordx2 s[6:7], s[0:1], 64
  s_load_dwordx2 s[8:9], s[0:1], 96
  s_load_dwordx4 s[60:63], s[0:1], 104
  v_and_b32 v1, 63, v0
  v_lshrrev_b32 v2, 6, v0
  s_nop 0
  v_readfirstlane_b32 s20, v2
  s_waitcnt lgkmcnt(0)
  s_cmp_ge_u32 s20, 4
  s_cbranch_scc1 L_g2_loader_79
  s_lshr_b32 s28, s20, 1
  s_and_b32 s29, s20, 1
  s_mov_b32 s32, s8
  s_and_b32 s33, s9, 0xffff
  s_mov_b32 s34, 9437184
  s_mov_b32 s35, 0x20000
  s_lshl_b32 s30, s27, 6
  s_lshl_b32 s31, s29, 5
  s_add_u32 s30, s30, s31
  v_and_b32 v2, 31, v1
  v_add_u32 v2, s30, v2
  v_lshrrev_b32 v3, 5, v1
  v_lshlrev_b32 v3, 2, v3
  s_lshl_b32 s31, s26, 7
  s_lshl_b32 s44, s28, 6
  s_add_u32 s31, s31, s44
  v_add_u32 v3, s31, v3
  v_mul_u32_u24 v40, 4608, v3
  v_lshlrev_b32 v4, 2, v2
  v_add_u32 v40, v40, v4
  s_mov_b32 s36, s4
  s_and_b32 s37, s5, 0xffff
  s_mov_b32 s38, 2359296
  s_mov_b32 s39, 0x20000
  s_mov_b32 s40, s6
  s_and_b32 s41, s7, 0xffff
  s_mov_b32 s42, 1152
  s_mov_b32 s43, 0x20000
  v_mul_u32_u24 v41, 1152, v3
  v_lshlrev_b32 v4, 1, v2
  v_add_u32 v41, v41, v4
  buffer_load_ushort v42, v4, s[40:43], 0 offen
  s_mov_b32 s45, 0
  buffer_load_ushort v44, v41, s[36:39], s45 offen
  s_mov_b32 s45, 1152
  buffer_load_ushort v45, v41, s[36:39], s45 offen
  s_mov_b32 s45, 2304
  buffer_load_ushort v46, v41, s[36:39], s45 offen
  s_mov_b32 s45, 3456
  buffer_load_ushort v47, v41, s[36:39], s45 offen
  s_mov_b32 s45, 9216
  buffer_load_ushort v48, v41, s[36:39], s45 offen
  s_mov_b32 s45, 10368
  buffer_load_ushort v49, v41, s[36:39], s45 offen
  s_mov_b32 s45, 11520
  buffer_load_ushort v50, v41, s[36:39], s45 offen
  s_mov_b32 s45, 12672
  buffer_load_ushort v51, v41, s[36:39], s45 offen
  s_mov_b32 s45, 18432
  buffer_load_ushort v52, v41, s[36:39], s45 offen
  s_mov_b32 s45, 19584
  buffer_load_ushort v53, v41, s[36:39], s45 offen
  s_mov_b32 s45, 20736
  buffer_load_ushort v54, v41, s[36:39], s45 offen
  s_mov_b32 s45, 21888
  buffer_load_ushort v55, v41, s[36:39], s45 offen
  s_mov_b32 s45, 27648
  buffer_load_ushort v56, v41, s[36:39], s45 offen
  s_mov_b32 s45, 28800
  buffer_load_ushort v57, v41, s[36:39], s45 offen
  s_mov_b32 s45, 29952
  buffer_load_ushort v58, v41, s[36:39], s45 offen
  s_mov_b32 s45, 31104
  buffer_load_ushort v59, v41, s[36:39], s45 offen
  s_mov_b32 s45, 36864
  buffer_load_ushort v60, v41, s[36:39], s45 offen
  s_mov_b32 s45, 38016
  buffer_load_ushort v61, v41, s[36:39], s45 offen
  s_mov_b32 s45, 39168
  buffer_load_ushort v62, v41, s[36:39], s45 offen
  s_mov_b32 s45, 40320
  buffer_load_ushort v63, v41, s[36:39], s45 offen
  s_mov_b32 s45, 46080
  buffer_load_ushort v64, v41, s[36:39], s45 offen
  s_mov_b32 s45, 47232
  buffer_load_ushort v65, v41, s[36:39], s45 offen
  s_mov_b32 s45, 48384
  buffer_load_ushort v66, v41, s[36:39], s45 offen
  s_mov_b32 s45, 49536
  buffer_load_ushort v67, v41, s[36:39], s45 offen
  s_mov_b32 s45, 55296
  buffer_load_ushort v68, v41, s[36:39], s45 offen
  s_mov_b32 s45, 56448
  buffer_load_ushort v69, v41, s[36:39], s45 offen
  s_mov_b32 s45, 57600
  buffer_load_ushort v70, v41, s[36:39], s45 offen
  s_mov_b32 s45, 58752
  buffer_load_ushort v71, v41, s[36:39], s45 offen
  s_mov_b32 s45, 64512
  buffer_load_ushort v72, v41, s[36:39], s45 offen
  s_mov_b32 s45, 65664
  buffer_load_ushort v73, v41, s[36:39], s45 offen
  s_mov_b32 s45, 66816
  buffer_load_ushort v74, v41, s[36:39], s45 offen
  s_mov_b32 s45, 67968
  buffer_load_ushort v75, v41, s[36:39], s45 offen
  v_mov_b32 v8, 0
  v_mov_b32 v9, 0
  v_mov_b32 v10, 0
  v_mov_b32 v11, 0
  v_mov_b32 v12, 0
  v_mov_b32 v13, 0
  v_mov_b32 v14, 0
  v_mov_b32 v15, 0
  v_mov_b32 v16, 0
  v_mov_b32 v17, 0
  v_mov_b32 v18, 0
  v_mov_b32 v19, 0
  v_mov_b32 v20, 0
  v_mov_b32 v21, 0
  v_mov_b32 v22, 0
  v_mov_b32 v23, 0
  v_mov_b32 v24, 0
  v_mov_b32 v25, 0
  v_mov_b32 v26, 0
  v_mov_b32 v27, 0
  v_mov_b32 v28, 0
  v_mov_b32 v29, 0
  v_mov_b32 v30, 0
  v_mov_b32 v31, 0
  v_mov_b32 v32, 0
  v_mov_b32 v33, 0
  v_mov_b32 v34, 0
  v_mov_b32 v35, 0
  v_mov_b32 v36, 0
  v_mov_b32 v37, 0
  v_mov_b32 v38, 0
  v_mov_b32 v39, 0
  s_lshl_b32 s28, s28, 12
  s_lshl_b32 s29, s29, 11
  v_and_b32 v2, 31, v1
  v_lshrrev_b32 v3, 2, v2
  v_and_b32 v3, 3, v3
  v_lshrrev_b32 v4, 5, v1
  v_xor_b32 v3, v3, v4
  v_lshlrev_b32 v3, 4, v3
  v_lshlrev_b32 v2, 6, v2
  v_add_u32 v2, v2, v3
  v_add_u32 v76, s28, v2
  v_add_u32 v77, s29, v2
  v_add_u32 v77, 16384, v77
  s_mov_b32 s25, 0
  v_add_u32 v78, s25, v76
  v_add_u32 v79, s25, v77
  v_xor_b32 v4, 32, v78
  v_xor_b32 v5, 32, v79
  s_add_u32 s25, s25, 24576
  s_cmp_ge_u32 s25, 73728
  s_cselect_b32 s25, 0, s25
  s_barrier
  ds_read_b128 v[80:83], v78 offset:0
  ds_read_b128 v[84:87], v78 offset:2048
  ds_read_b128 v[112:115], v79 offset:0
  ds_read_b128 v[88:91], v4 offset:0
  ds_read_b128 v[92:95], v4 offset:2048
  ds_read_b128 v[116:119], v5 offset:0
  ds_read_b128 v[96:99], v78 offset:8192
  ds_read_b128 v[100:103], v78 offset:10240
  ds_read_b128 v[120:123], v79 offset:4096
  s_mov_b32 s24, 0
L_c_loop_81:
  ds_read_b128 v[104:107], v4 offset:8192
  ds_read_b128 v[108:111], v4 offset:10240
  ds_read_b128 v[124:127], v5 offset:4096
  s_waitcnt lgkmcnt(9)
  v_mfma_f32_32x32x16_bf16 v[8:23], v[80:83], v[112:115], v[8:23]
  v_mfma_f32_32x32x16_bf16 v[24:39], v[84:87], v[112:115], v[24:39]
  v_add_u32 v78, s25, v76
  v_add_u32 v79, s25, v77
  v_xor_b32 v4, 32, v78
  v_xor_b32 v5, 32, v79
  s_add_u32 s25, s25, 24576
  s_cmp_ge_u32 s25, 73728
  s_cselect_b32 s25, 0, s25
  s_waitcnt lgkmcnt(0)
  s_barrier
  ds_read_b128 v[80:83], v78 offset:0
  ds_read_b128 v[84:87], v78 offset:2048
  ds_read_b128 v[112:115], v79 offset:0
  s_waitcnt lgkmcnt(9)
  v_mfma_f32_32x32x16_bf16 v[8:23], v[88:91], v[116:119], v[8:23]
  v_mfma_f32_32x32x16_bf16 v[24:39], v[92:95], v[116:119], v[24:39]
  ds_read_b128 v[88:91], v4 offset:0
  ds_read_b128 v[92:95], v4 offset:2048
  ds_read_b128 v[116:119], v5 offset:0
  s_waitcnt lgkmcnt(9)
  v_mfma_f32_32x32x16_bf16 v[8:23], v[96:99], v[120:123], v[8:23]
  v_mfma_f32_32x32x16_bf16 v[24:39], v[100:103], v[120:123], v[24:39]
  ds_read_b128 v[96:99], v78 offset:8192
  ds_read_b128 v[100:103], v78 offset:10240
  ds_read_b128 v[120:123], v79 offset:4096
  s_waitcnt lgkmcnt(9)
  v_mfma_f32_32x32x16_bf16 v[8:23], v[104:107], v[124:127], v[8:23]
  v_mfma_f32_32x32x16_bf16 v[24:39], v[108:111], v[124:127], v[24:39]
  s_add_u32 s24, s24, 1
  s_cmp_lt_u32 s24, 17
  s_cbranch_scc1 L_c_loop_81
  ds_read_b128 v[104:107], v4 offset:8192
  ds_read_b128 v[108:111], v4 offset:10240
  ds_read_b128 v[124:127], v5 offset:4096
  s_waitcnt lgkmcnt(9)
  v_mfma_f32_32x32x16_bf16 v[8:23], v[80:83], v[112:115], v[8:23]
  v_mfma_f32_32x32x16_bf16 v[24:39], v[84:87], v[112:115], v[24:39]
  s_waitcnt lgkmcnt(6)
  v_mfma_f32_32x32x16_bf16 v[8:23], v[88:91], v[116:119], v[8:23]
  v_mfma_f32_32x32x16_bf16 v[24:39], v[92:95], v[116:119], v[24:39]
  s_waitcnt lgkmcnt(3)
  v_mfma_f32_32x32x16_bf16 v[8:23], v[96:99], v[120:123], v[8:23]
  v_mfma_f32_32x32x16_bf16 v[24:39], v[100:103], v[120:123], v[24:39]
  s_waitcnt lgkmcnt(0)
  v_mfma_f32_32x32x16_bf16 v[8:23], v[104:107], v[124:127], v[8:23]
  v_mfma_f32_32x32x16_bf16 v[24:39], v[108:111], v[124:127], v[24:39]
  s_nop 15
  s_nop 3
  s_waitcnt vmcnt(0)
  v_lshlrev_b32 v42, 16, v42
  v_lshlrev_b32 v44, 16, v44
  v_fma_f32 v8, v44, v42, v8
  s_mov_b32 s45, 0
  buffer_store_dword v8, v40, s[32:35], s45 offen sc1 nt
  v_lshlrev_b32 v45, 16, v45
  v_fma_f32 v9, v45, v42, v9
  s_mov_b32 s45, 4608
  buffer_store_dword v9, v40, s[32:35], s45 offen sc1 nt
  v_lshlrev_b32 v46, 16, v46
  v_fma_f32 v10, v46, v42, v10
  s_mov_b32 s45, 9216
  buffer_store_dword v10, v40, s[32:35], s45 offen sc1 nt
  v_lshlrev_b32 v47, 16, v47
  v_fma_f32 v11, v47, v42, v11
  s_mov_b32 s45, 13824
  buffer_store_dword v11, v40, s[32:35], s45 offen sc1 nt
  v_lshlrev_b32 v48, 16, v48
  v_fma_f32 v12, v48, v42, v12
  s_mov_b32 s45, 36864
  buffer_store_dword v12, v40, s[32:35], s45 offen sc1 nt
  v_lshlrev_b32 v49, 16, v49
  v_fma_f32 v13, v49, v42, v13
  s_mov_b32 s45, 41472
  buffer_store_dword v13, v40, s[32:35], s45 offen sc1 nt
  v_lshlrev_b32 v50, 16, v50
  v_fma_f32 v14, v50, v42, v14
  s_mov_b32 s45, 46080
  buffer_store_dword v14, v40, s[32:35], s45 offen sc1 nt
  v_lshlrev_b32 v51, 16, v51
  v_fma_f32 v15, v51, v42, v15
  s_mov_b32 s45, 50688
  buffer_store_dword v15, v40, s[32:35], s45 offen sc1 nt
  v_lshlrev_b32 v52, 16, v52
  v_fma_f32 v16, v52, v42, v16
  s_mov_b32 s45, 73728
  buffer_store_dword v16, v40, s[32:35], s45 offen sc1 nt
  v_lshlrev_b32 v53, 16, v53
  v_fma_f32 v17, v53, v42, v17
  s_mov_b32 s45, 78336
  buffer_store_dword v17, v40, s[32:35], s45 offen sc1 nt
  v_lshlrev_b32 v54, 16, v54
  v_fma_f32 v18, v54, v42, v18
  s_mov_b32 s45, 82944
  buffer_store_dword v18, v40, s[32:35], s45 offen sc1 nt
  v_lshlrev_b32 v55, 16, v55
  v_fma_f32 v19, v55, v42, v19
  s_mov_b32 s45, 87552
  buffer_store_dword v19, v40, s[32:35], s45 offen sc1 nt
  v_lshlrev_b32 v56, 16, v56
  v_fma_f32 v20, v56, v42, v20
  s_mov_b32 s45, 110592
  buffer_store_dword v20, v40, s[32:35], s45 offen sc1 nt
  v_lshlrev_b32 v57, 16, v57
  v_fma_f32 v21, v57, v42, v21
  s_mov_b32 s45, 115200
  buffer_store_dword v21, v40, s[32:35], s45 offen sc1 nt
  v_lshlrev_b32 v58, 16, v58
  v_fma_f32 v22, v58, v42, v22
  s_mov_b32 s45, 119808
  buffer_store_dword v22, v40, s[32:35], s45 offen sc1 nt
  v_lshlrev_b32 v59, 16, v59
  v_fma_f32 v23, v59, v42, v23
  s_mov_b32 s45, 124416
  buffer_store_dword v23, v40, s[32:35], s45 offen sc1 nt
  v_lshlrev_b32 v60, 16, v60
  v_fma_f32 v24, v60, v42, v24
  s_mov_b32 s45, 147456
  buffer_store_dword v24, v40, s[32:35], s45 offen sc1 nt
  v_lshlrev_b32 v61, 16, v61
  v_fma_f32 v25, v61, v42, v25
  s_mov_b32 s45, 152064
  buffer_store_dword v25, v40, s[32:35], s45 offen sc1 nt
  v_lshlrev_b32 v62, 16, v62
  v_fma_f32 v26, v62, v42, v26
  s_mov_b32 s45, 156672
  buffer_store_dword v26, v40, s[32:35], s45 offen sc1 nt
  v_lshlrev_b32 v63, 16, v63
  v_fma_f32 v27, v63, v42, v27
  s_mov_b32 s45, 161280
  buffer_store_dword v27, v40, s[32:35], s45 offen sc1 nt
  v_lshlrev_b32 v64, 16, v64
  v_fma_f32 v28, v64, v42, v28
  s_mov_b32 s45, 184320
  buffer_store_dword v28, v40, s[32:35], s45 offen sc1 nt
  v_lshlrev_b32 v65, 16, v65
  v_fma_f32 v29, v65, v42, v29
  s_mov_b32 s45, 188928
  buffer_store_dword v29, v40, s[32:35], s45 offen sc1 nt
  v_lshlrev_b32 v66, 16, v66
  v_fma_f32 v30, v66, v42, v30
  s_mov_b32 s45, 193536
  buffer_store_dword v30, v40, s[32:35], s45 offen sc1 nt
  v_lshlrev_b32 v67, 16, v67
  v_fma_f32 v31, v67, v42, v31
  s_mov_b32 s45, 198144
  buffer_store_dword v31, v40, s[32:35], s45 offen sc1 nt
  v_lshlrev_b32 v68, 16, v68
  v_fma_f32 v32, v68, v42, v32
  s_mov_b32 s45, 221184
  buffer_store_dword v32, v40, s[32:35], s45 offen sc1 nt
  v_lshlrev_b32 v69, 16, v69
  v_fma_f32 v33, v69, v42, v33
  s_mov_b32 s45, 225792
  buffer_store_dword v33, v40, s[32:35], s45 offen sc1 nt
  v_lshlrev_b32 v70, 16, v70
  v_fma_f32 v34, v70, v42, v34
  s_mov_b32 s45, 230400
  buffer_store_dword v34, v40, s[32:35], s45 offen sc1 nt
  v_lshlrev_b32 v71, 16, v71
  v_fma_f32 v35, v71, v42, v35
  s_mov_b32 s45, 235008
  buffer_store_dword v35, v40, s[32:35], s45 offen sc1 nt
  v_lshlrev_b32 v72, 16, v72
  v_fma_f32 v36, v72, v42, v36
  s_mov_b32 s45, 258048
  buffer_store_dword v36, v40, s[32:35], s45 offen sc1 nt
  v_lshlrev_b32 v73, 16, v73
  v_fma_f32 v37, v73, v42, v37
  s_mov_b32 s45, 262656
  buffer_store_dword v37, v40, s[32:35], s45 offen sc1 nt
  v_lshlrev_b32 v74, 16, v74
  v_fma_f32 v38, v74, v42, v38
  s_mov_b32 s45, 267264
  buffer_store_dword v38, v40, s[32:35], s45 offen sc1 nt
  v_lshlrev_b32 v75, 16, v75
  v_fma_f32 v39, v75, v42, v39
  s_mov_b32 s45, 271872
  buffer_store_dword v39, v40, s[32:35], s45 offen sc1 nt
  s_branch L_g2_exit_80
L_g2_loader_79:
  s_mov_b32 s28, s62
  s_and_b32 s29, s63, 0xffff
  s_mov_b32 s30, 20262912
  s_mov_b32 s31, 0x20000
  s_lshl_b32 s46, s26, 8
  s_add_u32 s46, s46, 20254720
  v_mov_b32 v5, s46
  s_mov_b32 s48, 0
L_g2_poll_82:
  global_load_dword v4, v5, s[62:63] sc1
  s_waitcnt vmcnt(0)
  v_readfirstlane_b32 s47, v4
  s_cmp_ge_u32 s47, 72
  s_cbranch_scc1 L_g2_poll_82_ok
  s_sleep 8
  s_add_u32 s48, s48, 1
  s_cmp_lt_u32 s48, 400000
  s_cbranch_scc1 L_g2_poll_82
L_g2_poll_82_ok:
  s_sub_u32 s21, s20, 4
  v_lshlrev_b32 v8, 4, v1
  s_lshl_b32 s46, s21, 10
  s_mul_i32 s44, s26, 294912
  s_add_u32 s44, s44, s46
  s_add_u32 s44, s44, 11694080
  s_mul_i32 s45, s27, 147456
  s_add_u32 s45, s45, s46
  s_add_u32 s45, s45, 10366976
  s_lshl_b32 s22, s21, 10
  s_add_u32 m0, s22, 0
  s_add_u32 s23, s44, 0
  buffer_load_dwordx4 v8, s[28:31], s23 offen lds
  s_add_u32 m0, s22, 4096
  s_add_u32 s23, s44, 4096
  buffer_load_dwordx4 v8, s[28:31], s23 offen lds
  s_add_u32 m0, s22, 8192
  s_add_u32 s23, s44, 8192
  buffer_load_dwordx4 v8, s[28:31], s23 offen lds
  s_add_u32 m0, s22, 12288
  s_add_u32 s23, s44, 12288
  buffer_load_dwordx4 v8, s[28:31], s23 offen lds
  s_add_u32 m0, s22, 16384
  s_add_u32 s23, s45, 0
  buffer_load_dwordx4 v8, s[28:31], s23 offen lds
  s_add_u32 m0, s22, 20480
  s_add_u32 s23, s45, 4096
  buffer_load_dwordx4 v8, s[28:31], s23 offen lds
  s_add_u32 s44, s44, 16384
  s_add_u32 s45, s45, 8192
  s_add_u32 s22, s22, 24576
  s_sub_u32 s23, s22, 73728
  s_cmp_ge_u32 s22, 73728
  s_cselect_b32 s22, s23, s22
  s_add_u32 m0, s22, 0
  s_add_u32 s23, s44, 0
  buffer_load_dwordx4 v8, s[28:31], s23 offen lds
  s_add_u32 m0, s22, 4096
  s_add_u32 s23, s44, 4096
  buffer_load_dwordx4 v8, s[28:31], s23 offen lds
  s_add_u32 m0, s22, 8192
  s_add_u32 s23, s44, 8192
  buffer_load_dwordx4 v8, s[28:31], s23 offen lds
  s_add_u32 m0, s22, 12288
  s_add_u32 s23, s44, 12288
  buffer_load_dwordx4 v8, s[28:31], s23 offen lds
  s_add_u32 m0, s22, 16384
  s_add_u32 s23, s45, 0
  buffer_load_dwordx4 v8, s[28:31], s23 offen lds
  s_add_u32 m0, s22, 20480
  s_add_u32 s23, s45, 4096
  buffer_load_dwordx4 v8, s[28:31], s23 offen lds
  s_add_u32 s44, s44, 16384
  s_add_u32 s45, s45, 8192
  s_add_u32 s22, s22, 24576
  s_sub_u32 s23, s22, 73728
  s_cmp_ge_u32 s22, 73728
  s_cselect_b32 s22, s23, s22
  s_waitcnt vmcnt(6)
  s_barrier
  s_add_u32 m0, s22, 0
  s_add_u32 s23, s44, 0
  buffer_load_dwordx4 v8, s[28:31], s23 offen lds
  s_add_u32 m0, s22, 4096
  s_add_u32 s23, s44, 4096
  buffer_load_dwordx4 v8, s[28:31], s23 offen lds
  s_add_u32 m0, s22, 8192
  s_add_u32 s23, s44, 8192
  buffer_load_dwordx4 v8, s[28:31], s23 offen lds
  s_add_u32 m0, s22, 12288
  s_add_u32 s23, s44, 12288
  buffer_load_dwordx4 v8, s[28:31], s23 offen lds
  s_add_u32 m0, s22, 16384
  s_add_u32 s23, s45, 0
  buffer_load_dwordx4 v8, s[28:31], s23 offen lds
  s_add_u32 m0, s22, 20480
  s_add_u32 s23, s45, 4096
  buffer_load_dwordx4 v8, s[28:31], s23 offen lds
  s_add_u32 s44, s44, 16384
  s_add_u32 s45, s45, 8192
  s_add_u32 s22, s22, 24576
  s_sub_u32 s23, s22, 73728
  s_cmp_ge_u32 s22, 73728
  s_cselect_b32 s22, s23, s22
  s_mov_b32 s24, 1
L_ld_loop_83:
  s_cmp_ge_u32 s24, 17
  s_cbranch_scc0 L_ld_w_85
  s_waitcnt vmcnt(0)
L_ld_w_85:
  s_waitcnt vmcnt(6)
  s_barrier
  s_cmp_ge_u32 s24, 16
  s_cbranch_scc1 L_ld_tail_84
  s_add_u32 m0, s22, 0
  s_add_u32 s23, s44, 0
  buffer_load_dwordx4 v8, s[28:31], s23 offen lds
  s_add_u32 m0, s22, 4096
  s_add_u32 s23, s44, 4096
  buffer_load_dwordx4 v8, s[28:31], s23 offen lds
  s_add_u32 m0, s22, 8192
  s_add_u32 s23, s44, 8192
  buffer_load_dwordx4 v8, s[28:31], s23 offen lds
  s_add_u32 m0, s22, 12288
  s_add_u32 s23, s44, 12288
  buffer_load_dwordx4 v8, s[28:31], s23 offen lds
  s_add_u32 m0, s22, 16384
  s_add_u32 s23, s45, 0
  buffer_load_dwordx4 v8, s[28:31], s23 offen lds
  s_add_u32 m0, s22, 20480
  s_add_u32 s23, s45, 4096
  buffer_load_dwordx4 v8, s[28:31], s23 offen lds
  s_add_u32 s44, s44, 16384
  s_add_u32 s45, s45, 8192
  s_add_u32 s22, s22, 24576
  s_sub_u32 s23, s22, 73728
  s_cmp_ge_u32 s22, 73728
  s_cselect_b32 s22, s23, s22
L_ld_tail_84:
  s_add_u32 s24, s24, 1
  s_cmp_lt_u32 s24, 18
  s_cbranch_scc1 L_ld_loop_83
  s_branch L_g2_exit_80
L_g2_exit_80:
  s_branch L_k2_o
L_k2_o:
  s_lshr_b32 s5, s3, 3
  s_cmp_ge_u32 s5, 22
  s_cbranch_scc1 L_k2_o_a
  s_cmp_lt_u32 s5, 8
  s_cbranch_scc0 L_k2_fin
  s_add_u32 s5, s5, 32
L_k2_o_a:
  s_sub_u32 s5, s5, 22
  s_barrier
  s_cmp_ge_u32 s5, 9
  s_cselect_b32 s26, 8, 0
  s_cselect_b32 s27, 9, 0
  s_sub_u32 s27, s5, s27
  s_and_b32 s4, s3, 7
  s_add_u32 s26, s26, s4
  s_setprio 3
  s_load_dwordx2 s[8:9], s[0:1], 96
  s_load_dwordx2 s[62:63], s[0:1], 112
  v_and_b32 v1, 63, v0
  v_lshrrev_b32 v2, 6, v0
  s_nop 0
  v_readfirstlane_b32 s20, v2
  s_waitcnt lgkmcnt(0)
  s_mov_b32 s28, s62
  s_and_b32 s29, s63, 0xffff
  s_mov_b32 s30, 20262912
  s_mov_b32 s31, 0x20000
  s_cmp_ge_u32 s20, 4
  s_cbranch_scc1 L_o2_loader_86
  s_mov_b32 s32, s8
  s_and_b32 s33, s9, 0xffff
  s_mov_b32 s34, 9437184
  s_mov_b32 s35, 0x20000
  v_and_b32 v2, 31, v1
  v_lshrrev_b32 v3, 5, v1
  v_lshrrev_b32 v4, 3, v2
  v_and_b32 v4, 1, v4
  v_xor_b32 v4, v4, v3
  v_lshlrev_b32 v4, 4, v4
  v_lshlrev_b32 v40, 5, v2
  v_add_u32 v40, v40, v4
  v_lshlrev_b32 v41, 11, v3
  v_lshlrev_b32 v4, 2, v2
  v_add_u32 v41, v41, v4
  v_lshrrev_b32 v4, 2, v2
  v_and_b32 v4, 3, v4
  v_xor_b32 v4, v4, v3
  v_lshlrev_b32 v4, 4, v4
  v_lshlrev_b32 v43, 6, v2
  v_add_u32 v43, v43, v4
  v_xor_b32 v44, 32, v43
  v_add_u32 v45, 36864, v43
  v_add_u32 v46, 36864, v44
  s_lshl_b32 s50, s26, 7
  s_lshl_b32 s51, s20, 5
  s_add_u32 s50, s50, s51
  v_lshlrev_b32 v4, 2, v3
  v_add_u32 v4, s50, v4
  v_mul_u32_u24 v42, 4608, v4
  s_lshl_b32 s51, s27, 6
  s_add_u32 s51, s51, 576
  v_add_u32 v4, s51, v2
  v_lshlrev_b32 v4, 2, v4
  v_add_u32 v42, v42, v4
  s_mul_i32 s44, s26, 147456
  s_add_u32 s44, s44, 7344128
  s_lshl_b32 s45, s20, 7
  s_add_u32 s45, s45, s44
  s_add_u32 s45, s45, 131072
  s_lshl_b32 s46, s20, 10
  s_add_u32 s44, s44, s46
  v_mov_b32 v8, 0
  v_mov_b32 v9, 0
  v_mov_b32 v10, 0
  v_mov_b32 v11, 0
  v_mov_b32 v12, 0
  v_mov_b32 v13, 0
  v_mov_b32 v14, 0
  v_mov_b32 v15, 0
  v_mov_b32 v16, 0
  v_mov_b32 v17, 0
  v_mov_b32 v18, 0
  v_mov_b32 v19, 0
  v_mov_b32 v20, 0
  v_mov_b32 v21, 0
  v_mov_b32 v22, 0
  v_mov_b32 v23, 0
  v_mov_b32 v24, 0
  v_mov_b32 v25, 0
  v_mov_b32 v26, 0
  v_mov_b32 v27, 0
  v_mov_b32 v28, 0
  v_mov_b32 v29, 0
  v_mov_b32 v30, 0
  v_mov_b32 v31, 0
  v_mov_b32 v32, 0
  v_mov_b32 v33, 0
  v_mov_b32 v34, 0
  v_mov_b32 v35, 0
  v_mov_b32 v36, 0
  v_mov_b32 v37, 0
  v_mov_b32 v38, 0
  v_mov_b32 v39, 0
  s_barrier
  s_mov_b32 s48, 0
  s_mov_b32 s47, s44
  s_mov_b32 s46, s45
  v_and_b32 v5, 31, v1
  v_lshlrev_b32 v5, 9, v5
L_o2_pre_88:
  buffer_load_dword v4, v5, s[28:31], s45 offen sc1
  s_waitcnt vmcnt(0)
  v_cmp_eq_u32 vcc, -1, v4
  s_nop 1
  s_cbranch_vccz L_o2_pre_88_ok
  s_sleep 6
  s_add_u32 s48, s48, 1
  s_cmp_lt_u32 s48, 60000
  s_cbranch_scc1 L_o2_pre_88
L_o2_pre_88_ok:
L_o2_main_89:
  buffer_load_dwordx4 v[48:51], v40, s[28:31], s44 offen sc1
  s_add_u32 s44, s44, 4096
  buffer_load_dwordx4 v[52:55], v40, s[28:31], s44 offen sc1
  s_add_u32 s44, s44, 4096
  buffer_load_dwordx4 v[56:59], v40, s[28:31], s44 offen sc1
  s_add_u32 s44, s44, 4096
  buffer_load_dwordx4 v[60:63], v40, s[28:31], s44 offen sc1
  s_add_u32 s44, s44, 4096
  buffer_load_dwordx4 v[64:67], v40, s[28:31], s44 offen sc1
  s_add_u32 s44, s44, 4096
  buffer_load_dwordx4 v[68:71], v40, s[28:31], s44 offen sc1
  s_add_u32 s44, s44, 4096
  buffer_load_dwordx4 v[72:75], v40, s[28:31], s44 offen sc1
  s_add_u32 s44, s44, 4096
  buffer_load_dwordx4 v[76:79], v40, s[28:31], s44 offen sc1
  s_add_u32 s44, s44, 4096
  buffer_load_dwordx4 v[80:83], v40, s[28:31], s44 offen sc1
  s_add_u32 s44, s44, 4096
  buffer_load_dwordx4 v[84:87], v40, s[28:31], s44 offen sc1
  s_add_u32 s44, s44, 4096
  buffer_load_dwordx4 v[88:91], v40, s[28:31], s44 offen sc1
  s_add_u32 s44, s44, 4096
  buffer_load_dwordx4 v[92:95], v40, s[28:31], s44 offen sc1
  s_add_u32 s44, s44, 4096
  ds_read_b128 v[96:99], v43 offset:0
  ds_read_b128 v[100:103], v43 offset:2048
  ds_read_b128 v[104:107], v44 offset:0
  ds_read_b128 v[108:111], v44 offset:2048
  s_waitcnt vmcnt(11) lgkmcnt(2)
L_o2_chk_91:
  v_max3_u32 v4, v48, v49, v50
  v_max_u32 v4, v4, v51
  v_cmp_eq_u32 vcc, -1, v4
  s_nop 1
  s_cbranch_vccnz L_o2_re_92
L_o2_chk_91_go:
  v_mfma_f32_32x32x16_bf16 v[8:23], v[48:51], v[96:99], v[8:23]
  v_mfma_f32_32x32x16_bf16 v[24:39], v[48:51], v[100:103], v[24:39]
  buffer_load_dwordx4 v[48:51], v40, s[28:31], s44 offen sc1
  s_add_u32 s44, s44, 4096
  ds_read_b128 v[96:99], v43 offset:4096
  ds_read_b128 v[100:103], v43 offset:6144
  s_waitcnt vmcnt(11) lgkmcnt(2)
L_o2_chk_93:
  v_max3_u32 v4, v52, v53, v54
  v_max_u32 v4, v4, v55
  v_cmp_eq_u32 vcc, -1, v4
  s_nop 1
  s_cbranch_vccnz L_o2_re_94
L_o2_chk_93_go:
  v_mfma_f32_32x32x16_bf16 v[8:23], v[52:55], v[104:107], v[8:23]
  v_mfma_f32_32x32x16_bf16 v[24:39], v[52:55], v[108:111], v[24:39]
  buffer_load_dwordx4 v[52:55], v40, s[28:31], s44 offen sc1
  s_add_u32 s44, s44, 4096
  ds_read_b128 v[104:107], v44 offset:4096
  ds_read_b128 v[108:111], v44 offset:6144
  s_waitcnt vmcnt(11) lgkmcnt(2)
L_o2_chk_95:
  v_max3_u32 v4, v56, v57, v58
  v_max_u32 v4, v4, v59
  v_cmp_eq_u32 vcc, -1, v4
  s_nop 1
  s_cbranch_vccnz L_o2_re_96
L_o2_chk_95_go:
  v_mfma_f32_32x32x16_bf16 v[8:23], v[56:59], v[96:99], v[8:23]
  v_mfma_f32_32x32x16_bf16 v[24:39], v[56:59], v[100:103], v[24:39]
  buffer_load_dwordx4 v[56:59], v40, s[28:31], s44 offen sc1
  s_add_u32 s44, s44, 4096
  ds_read_b128 v[96:99], v43 offset:8192
  ds_read_b128 v[100:103], v43 offset:10240
  s_waitcnt vmcnt(11) lgkmcnt(2)
L_o2_chk_97:
  v_max3_u32 v4, v60, v61, v62
  v_max_u32 v4, v4, v63
  v_cmp_eq_u32 vcc, -1, v4
  s_nop 1
  s_cbranch_vccnz L_o2_re_98
L_o2_chk_97_go:
  v_mfma_f32_32x32x16_bf16 v[8:23], v[60:63], v[104:107], v[8:23]
  v_mfma_f32_32x32x16_bf16 v[24:39], v[60:63], v[108:111], v[24:39]
  buffer_load_dwordx4 v[60:63], v40, s[28:31], s44 offen sc1
  s_add_u32 s44, s44, 4096
  ds_read_b128 v[104:107], v44 offset:8192
  ds_read_b128 v[108:111], v44 offset:10240
  s_waitcnt vmcnt(11) lgkmcnt(2)
L_o2_chk_99:
  v_max3_u32 v4, v64, v65, v66
  v_max_u32 v4, v4, v67
  v_cmp_eq_u32 vcc, -1, v4
  s_nop 1
  s_cbranch_vccnz L_o2_re_100
L_o2_chk_99_go:
  v_mfma_f32_32x32x16_bf16 v[8:23], v[64:67], v[96:99], v[8:23]
  v_mfma_f32_32x32x16_bf16 v[24:39], v[64:67], v[100:103], v[24:39]
  buffer_load_dwordx4 v[64:67], v40, s[28:31], s44 offen sc1
  s_add_u32 s44, s44, 4096
  ds_read_b128 v[96:99], v43 offset:12288
  ds_read_b128 v[100:103], v43 offset:14336
  s_waitcnt vmcnt(11) lgkmcnt(2)
L_o2_chk_101:
  v_max3_u32 v4, v68, v69, v70
  v_max_u32 v4, v4, v71
  v_cmp_eq_u32 vcc, -1, v4
  s_nop 1
  s_cbranch_vccnz L_o2_re_102
L_o2_chk_101_go:
  v_mfma_f32_32x32x16_bf16 v[8:23], v[68:71], v[104:107], v[8:23]
  v_mfma_f32_32x32x16_bf16 v[24:39], v[68:71], v[108:111], v[24:39]
  buffer_load_dwordx4 v[68:71], v40, s[28:31], s44 offen sc1
  s_add_u32 s44, s44, 4096
  ds_read_b128 v[104:107], v44 offset:12288
  ds_read_b128 v[108:111], v44 offset:14336
  s_waitcnt vmcnt(11) lgkmcnt(2)
L_o2_chk_103:
  v_max3_u32 v4, v72, v73, v74
  v_max_u32 v4, v4, v75
  v_cmp_eq_u32 vcc, -1, v4
  s_nop 1
  s_cbranch_vccnz L_o2_re_104
L_o2_chk_103_go:
  v_mfma_f32_32x32x16_bf16 v[8:23], v[72:75], v[96:99], v[8:23]
  v_mfma_f32_32x32x16_bf16 v[24:39], v[72:75], v[100:103], v[24:39]
  buffer_load_dwordx4 v[72:75], v40, s[28:31], s44 offen sc1
  s_add_u32 s44, s44, 4096
  ds_read_b128 v[96:99], v43 offset:16384
  ds_read_b128 v[100:103], v43 offset:18432
  s_waitcnt vmcnt(11) lgkmcnt(2)
L_o2_chk_105:
  v_max3_u32 v4, v76, v77, v78
  v_max_u32 v4, v4, v79
  v_cmp_eq_u32 vcc, -1, v4
  s_nop 1
  s_cbranch_vccnz L_o2_re_106
L_o2_chk_105_go:
  v_mfma_f32_32x32x16_bf16 v[8:23], v[76:79], v[104:107], v[8:23]
  v_mfma_f32_32x32x16_bf16 v[24:39], v[76:79], v[108:111], v[24:39]
  buffer_load_dwordx4 v[76:79], v40, s[28:31], s44 offen sc1
  s_add_u32 s44, s44, 4096
  ds_read_b128 v[104:107], v44 offset:16384
  ds_read_b128 v[108:111], v44 offset:18432
  s_waitcnt vmcnt(11) lgkmcnt(2)
L_o2_chk_107:
  v_max3_u32 v4, v80, v81, v82
  v_max_u32 v4, v4, v83
  v_cmp_eq_u32 vcc, -1, v4
  s_nop 1
  s_cbranch_vccnz L_o2_re_108
L_o2_chk_107_go:
  v_mfma_f32_32x32x16_bf16 v[8:23], v[80:83], v[96:99], v[8:23]
  v_mfma_f32_32x32x16_bf16 v[24:39], v[80:83], v[100:103], v[24:39]
  buffer_load_dwordx4 v[80:83], v40, s[28:31], s44 offen sc1
  s_add_u32 s44, s44, 4096
  ds_read_b128 v[96:99], v43 offset:20480
  ds_read_b128 v[100:103], v43 offset:22528
  s_waitcnt vmcnt(11) lgkmcnt(2)
L_o2_chk_109:
  v_max3_u32 v4, v84, v85, v86
  v_max_u32 v4, v4, v87
  v_cmp_eq_u32 vcc, -1, v4
  s_nop 1
  s_cbranch_vccnz L_o2_re_110
L_o2_chk_109_go:
  v_mfma_f32_32x32x16_bf16 v[8:23], v[84:87], v[104:107], v[8:23]
  v_mfma_f32_32x32x16_bf16 v[24:39], v[84:87], v[108:111], v[24:39]
  buffer_load_dwordx4 v[84:87], v40, s[28:31], s44 offen sc1
  s_add_u32 s44, s44, 4096
  ds_read_b128 v[104:107], v44 offset:20480
  ds_read_b128 v[108:111], v44 offset:22528
  s_waitcnt vmcnt(11) lgkmcnt(2)
L_o2_chk_111:
  v_max3_u32 v4, v88, v89, v90
  v_max_u32 v4, v4, v91
  v_cmp_eq_u32 vcc, -1, v4
  s_nop 1
  s_cbranch_vccnz L_o2_re_112
L_o2_chk_111_go:
  v_mfma_f32_32x32x16_bf16 v[8:23], v[88:91], v[96:99], v[8:23]
  v_mfma_f32_32x32x16_bf16 v[24:39], v[88:91], v[100:103], v[24:39]
  buffer_load_dwordx4 v[88:91], v40, s[28:31], s44 offen sc1
  s_add_u32 s44, s44, 4096
  ds_read_b128 v[96:99], v43 offset:24576
  ds_read_b128 v[100:103], v43 offset:26624
  s_waitcnt vmcnt(11) lgkmcnt(2)
L_o2_chk_113:
  v_max3_u32 v4, v92, v93, v94
  v_max_u32 v4, v4, v95
  v_cmp_eq_u32 vcc, -1, v4
  s_nop 1
  s_cbranch_vccnz L_o2_re_114
L_o2_chk_113_go:
  v_mfma_f32_32x32x16_bf16 v[8:23], v[92:95], v[104:107], v[8:23]
  v_mfma_f32_32x32x16_bf16 v[24:39], v[92:95], v[108:111], v[24:39]
  buffer_load_dwordx4 v[92:95], v40, s[28:31], s44 offen sc1
  s_add_u32 s44, s44, 4096
  ds_read_b128 v[104:107], v44 offset:24576
  ds_read_b128 v[108:111], v44 offset:26624
  s_waitcnt vmcnt(11) lgkmcnt(2)
L_o2_chk_115:
  v_max3_u32 v4, v48, v49, v50
  v_max_u32 v4, v4, v51
  v_cmp_eq_u32 vcc, -1, v4
  s_nop 1
  s_cbranch_vccnz L_o2_re_116
L_o2_chk_115_go:
  v_mfma_f32_32x32x16_bf16 v[8:23], v[48:51], v[96:99], v[8:23]
  v_mfma_f32_32x32x16_bf16 v[24:39], v[48:51], v[100:103], v[24:39]
  buffer_load_dwordx4 v[48:51], v40, s[28:31], s44 offen sc1
  s_add_u32 s44, s44, 4096
  ds_read_b128 v[96:99], v43 offset:28672
  ds_read_b128 v[100:103], v43 offset:30720
  s_waitcnt vmcnt(11) lgkmcnt(2)
L_o2_chk_117:
  v_max3_u32 v4, v52, v53, v54
  v_max_u32 v4, v4, v55
  v_cmp_eq_u32 vcc, -1, v4
  s_nop 1
  s_cbranch_vccnz L_o2_re_118
L_o2_chk_117_go:
  v_mfma_f32_32x32x16_bf16 v[8:23], v[52:55], v[104:107], v[8:23]
  v_mfma_f32_32x32x16_bf16 v[24:39], v[52:55], v[108:111], v[24:39]
  buffer_load_dwordx4 v[52:55], v40, s[28:31], s44 offen sc1
  s_add_u32 s44, s44, 4096
  ds_read_b128 v[104:107], v44 offset:28672
  ds_read_b128 v[108:111], v44 offset:30720
  s_waitcnt vmcnt(11) lgkmcnt(2)
L_o2_chk_119:
  v_max3_u32 v4, v56, v57, v58
  v_max_u32 v4, v4, v59
  v_cmp_eq_u32 vcc, -1, v4
  s_nop 1
  s_cbranch_vccnz L_o2_re_120
L_o2_chk_119_go:
  v_mfma_f32_32x32x16_bf16 v[8:23], v[56:59], v[96:99], v[8:23]
  v_mfma_f32_32x32x16_bf16 v[24:39], v[56:59], v[100:103], v[24:39]
  buffer_load_dwordx4 v[56:59], v40, s[28:31], s44 offen sc1
  s_add_u32 s44, s44, 4096
  ds_read_b128 v[96:99], v43 offset:32768
  ds_read_b128 v[100:103], v43 offset:34816
  s_waitcnt vmcnt(11) lgkmcnt(2)
L_o2_chk_121:
  v_max3_u32 v4, v60, v61, v62
  v_max_u32 v4, v4, v63
  v_cmp_eq_u32 vcc, -1, v4
  s_nop 1
  s_cbranch_vccnz L_o2_re_122
L_o2_chk_121_go:
  v_mfma_f32_32x32x16_bf16 v[8:23], v[60:63], v[104:107], v[8:23]
  v_mfma_f32_32x32x16_bf16 v[24:39], v[60:63], v[108:111], v[24:39]
  buffer_load_dwordx4 v[60:63], v40, s[28:31], s44 offen sc1
  s_add_u32 s44, s44, 4096
  ds_read_b128 v[104:107], v44 offset:32768
  ds_read_b128 v[108:111], v44 offset:34816
  s_waitcnt vmcnt(11) lgkmcnt(2)
L_o2_chk_123:
  v_max3_u32 v4, v64, v65, v66
  v_max_u32 v4, v4, v67
  v_cmp_eq_u32 vcc, -1, v4
  s_nop 1
  s_cbranch_vccnz L_o2_re_124
L_o2_chk_123_go:
  v_mfma_f32_32x32x16_bf16 v[8:23], v[64:67], v[96:99], v[8:23]
  v_mfma_f32_32x32x16_bf16 v[24:39], v[64:67], v[100:103], v[24:39]
  buffer_load_dwordx4 v[64:67], v40, s[28:31], s44 offen sc1
  s_add_u32 s44, s44, 4096
  ds_read_b128 v[96:99], v45 offset:0
  ds_read_b128 v[100:103], v45 offset:2048
  s_waitcnt vmcnt(11) lgkmcnt(2)
L_o2_chk_125:
  v_max3_u32 v4, v68, v69, v70
  v_max_u32 v4, v4, v71
  v_cmp_eq_u32 vcc, -1, v4
  s_nop 1
  s_cbranch_vccnz L_o2_re_126
L_o2_chk_125_go:
  v_mfma_f32_32x32x16_bf16 v[8:23], v[68:71], v[104:107], v[8:23]
  v_mfma_f32_32x32x16_bf16 v[24:39], v[68:71], v[108:111], v[24:39]
  buffer_load_dwordx4 v[68:71], v40, s[28:31], s44 offen sc1
  s_add_u32 s44, s44, 4096
  ds_read_b128 v[104:107], v46 offset:0
  ds_read_b128 v[108:111], v46 offset:2048
  s_waitcnt vmcnt(11) lgkmcnt(2)
L_o2_chk_127:
  v_max3_u32 v4, v72, v73, v74
  v_max_u32 v4, v4, v75
  v_cmp_eq_u32 vcc, -1, v4
  s_nop 1
  s_cbranch_vccnz L_o2_re_128
L_o2_chk_127_go:
  v_mfma_f32_32x32x16_bf16 v[8:23], v[72:75], v[96:99], v[8:23]
  v_mfma_f32_32x32x16_bf16 v[24:39], v[72:75], v[100:103], v[24:39]
  buffer_load_dwordx4 v[72:75], v40, s[28:31], s44 offen sc1
  s_add_u32 s44, s44, 4096
  ds_read_b128 v[96:99], v45 offset:4096
  ds_read_b128 v[100:103], v45 offset:6144
  s_waitcnt vmcnt(11) lgkmcnt(2)
L_o2_chk_129:
  v_max3_u32 v4, v76, v77, v78
  v_max_u32 v4, v4, v79
  v_cmp_eq_u32 vcc, -1, v4
  s_nop 1
  s_cbranch_vccnz L_o2_re_130
L_o2_chk_129_go:
  v_mfma_f32_32x32x16_bf16 v[8:23], v[76:79], v[104:107], v[8:23]
  v_mfma_f32_32x32x16_bf16 v[24:39], v[76:79], v[108:111], v[24:39]
  buffer_load_dwordx4 v[76:79], v40, s[28:31], s44 offen sc1
  s_add_u32 s44, s44, 4096
  ds_read_b128 v[104:107], v46 offset:4096
  ds_read_b128 v[108:111], v46 offset:6144
  s_waitcnt vmcnt(11) lgkmcnt(2)
L_o2_chk_131:
  v_max3_u32 v4, v80, v81, v82
  v_max_u32 v4, v4, v83
  v_cmp_eq_u32 vcc, -1, v4
  s_nop 1
  s_cbranch_vccnz L_o2_re_132
L_o2_chk_131_go:
  v_mfma_f32_32x32x16_bf16 v[8:23], v[80:83], v[96:99], v[8:23]
  v_mfma_f32_32x32x16_bf16 v[24:39], v[80:83], v[100:103], v[24:39]
  buffer_load_dword v80, v41, s[28:31], s45 offen offset:0 sc1
  buffer_load_dword v81, v41, s[28:31], s45 offen offset:512 sc1
  buffer_load_dword v82, v41, s[28:31], s45 offen offset:1024 sc1
  buffer_load_dword v83, v41, s[28:31], s45 offen offset:1536 sc1
  s_add_u32 s45, s45, 4096
  ds_read_b128 v[96:99], v45 offset:8192
  ds_read_b128 v[100:103], v45 offset:10240
  s_waitcnt vmcnt(14) lgkmcnt(2)
L_o2_chk_133:
  v_max3_u32 v4, v84, v85, v86
  v_max_u32 v4, v4, v87
  v_cmp_eq_u32 vcc, -1, v4
  s_nop 1
  s_cbranch_vccnz L_o2_re_134
L_o2_chk_133_go:
  v_mfma_f32_32x32x16_bf16 v[8:23], v[84:87], v[104:107], v[8:23]
  v_mfma_f32_32x32x16_bf16 v[24:39], v[84:87], v[108:111], v[24:39]
  buffer_load_dword v84, v41, s[28:31], s45 offen offset:0 sc1
  buffer_load_dword v85, v41, s[28:31], s45 offen offset:512 sc1
  buffer_load_dword v86, v41, s[28:31], s45 offen offset:1024 sc1
  buffer_load_dword v87, v41, s[28:31], s45 offen offset:1536 sc1
  s_add_u32 s45, s45, 4096
  ds_read_b128 v[104:107], v46 offset:8192
  ds_read_b128 v[108:111], v46 offset:10240
  s_waitcnt vmcnt(17) lgkmcnt(2)
L_o2_chk_135:
  v_max3_u32 v4, v88, v89, v90
  v_max_u32 v4, v4, v91
  v_cmp_eq_u32 vcc, -1, v4
  s_nop 1
  s_cbranch_vccnz L_o2_re_136
L_o2_chk_135_go:
  v_mfma_f32_32x32x16_bf16 v[8:23], v[88:91], v[96:99], v[8:23]
  v_mfma_f32_32x32x16_bf16 v[24:39], v[88:91], v[100:103], v[24:39]
  buffer_load_dword v88, v41, s[28:31], s45 offen offset:0 sc1
  buffer_load_dword v89, v41, s[28:31], s45 offen offset:512 sc1
  buffer_load_dword v90, v41, s[28:31], s45 offen offset:1024 sc1
  buffer_load_dword v91, v41, s[28:31], s45 offen offset:1536 sc1
  s_add_u32 s45, s45, 4096
  ds_read_b128 v[96:99], v45 offset:12288
  ds_read_b128 v[100:103], v45 offset:14336
  s_waitcnt vmcnt(20) lgkmcnt(2)
L_o2_chk_137:
  v_max3_u32 v4, v92, v93, v94
  v_max_u32 v4, v4, v95
  v_cmp_eq_u32 vcc, -1, v4
  s_nop 1
  s_cbranch_vccnz L_o2_re_138
L_o2_chk_137_go:
  v_mfma_f32_32x32x16_bf16 v[8:23], v[92:95], v[104:107], v[8:23]
  v_mfma_f32_32x32x16_bf16 v[24:39], v[92:95], v[108:111], v[24:39]
  buffer_load_dword v92, v41, s[28:31], s45 offen offset:0 sc1
  buffer_load_dword v93, v41, s[28:31], s45 offen offset:512 sc1
  buffer_load_dword v94, v41, s[28:31], s45 offen offset:1024 sc1
  buffer_load_dword v95, v41, s[28:31], s45 offen offset:1536 sc1
  s_add_u32 s45, s45, 4096
  ds_read_b128 v[104:107], v46 offset:12288
  ds_read_b128 v[108:111], v46 offset:14336
  s_waitcnt vmcnt(23) lgkmcnt(2)
L_o2_chk_139:
  v_max3_u32 v4, v48, v49, v50
  v_max_u32 v4, v4, v51
  v_cmp_eq_u32 vcc, -1, v4
  s_nop 1
  s_cbranch_vccnz L_o2_re_140
L_o2_chk_139_go:
  v_mfma_f32_32x32x16_bf16 v[8:23], v[48:51], v[96:99], v[8:23]
  v_mfma_f32_32x32x16_bf16 v[24:39], v[48:51], v[100:103], v[24:39]
  ds_read_b128 v[96:99], v45 offset:16384
  ds_read_b128 v[100:103], v45 offset:18432
  s_waitcnt vmcnt(22) lgkmcnt(2)
L_o2_chk_141:
  v_max3_u32 v4, v52, v53, v54
  v_max_u32 v4, v4, v55
  v_cmp_eq_u32 vcc, -1, v4
  s_nop 1
  s_cbranch_vccnz L_o2_re_142
L_o2_chk_141_go:
  v_mfma_f32_32x32x16_bf16 v[8:23], v[52:55], v[104:107], v[8:23]
  v_mfma_f32_32x32x16_bf16 v[24:39], v[52:55], v[108:111], v[24:39]
  ds_read_b128 v[104:107], v46 offset:16384
  ds_read_b128 v[108:111], v46 offset:18432
  s_waitcnt vmcnt(21) lgkmcnt(2)
L_o2_chk_143:
  v_max3_u32 v4, v56, v57, v58
  v_max_u32 v4, v4, v59
  v_cmp_eq_u32 vcc, -1, v4
  s_nop 1
  s_cbranch_vccnz L_o2_re_144
L_o2_chk_143_go:
  v_mfma_f32_32x32x16_bf16 v[8:23], v[56:59], v[96:99], v[8:23]
  v_mfma_f32_32x32x16_bf16 v[24:39], v[56:59], v[100:103], v[24:39]
  ds_read_b128 v[96:99], v45 offset:20480
  ds_read_b128 v[100:103], v45 offset:22528
  s_waitcnt vmcnt(20) lgkmcnt(2)
L_o2_chk_145:
  v_max3_u32 v4, v60, v61, v62
  v_max_u32 v4, v4, v63
  v_cmp_eq_u32 vcc, -1, v4
  s_nop 1
  s_cbranch_vccnz L_o2_re_146
L_o2_chk_145_go:
  v_mfma_f32_32x32x16_bf16 v[8:23], v[60:63], v[104:107], v[8:23]
  v_mfma_f32_32x32x16_bf16 v[24:39], v[60:63], v[108:111], v[24:39]
  ds_read_b128 v[104:107], v46 offset:20480
  ds_read_b128 v[108:111], v46 offset:22528
  s_waitcnt vmcnt(19) lgkmcnt(2)
L_o2_chk_147:
  v_max3_u32 v4, v64, v65, v66
  v_max_u32 v4, v4, v67
  v_cmp_eq_u32 vcc, -1, v4
  s_nop 1
  s_cbranch_vccnz L_o2_re_148
L_o2_chk_147_go:
  v_mfma_f32_32x32x16_bf16 v[8:23], v[64:67], v[96:99], v[8:23]
  v_mfma_f32_32x32x16_bf16 v[24:39], v[64:67], v[100:103], v[24:39]
  ds_read_b128 v[96:99], v45 offset:24576
  ds_read_b128 v[100:103], v45 offset:26624
  s_waitcnt vmcnt(18) lgkmcnt(2)
L_o2_chk_149:
  v_max3_u32 v4, v68, v69, v70
  v_max_u32 v4, v4, v71
  v_cmp_eq_u32 vcc, -1, v4
  s_nop 1
  s_cbranch_vccnz L_o2_re_150
L_o2_chk_149_go:
  v_mfma_f32_32x32x16_bf16 v[8:23], v[68:71], v[104:107], v[8:23]
  v_mfma_f32_32x32x16_bf16 v[24:39], v[68:71], v[108:111], v[24:39]
  ds_read_b128 v[104:107], v46 offset:24576
  ds_read_b128 v[108:111], v46 offset:26624
  s_waitcnt vmcnt(17) lgkmcnt(2)
L_o2_chk_151:
  v_max3_u32 v4, v72, v73, v74
  v_max_u32 v4, v4, v75
  v_cmp_eq_u32 vcc, -1, v4
  s_nop 1
  s_cbranch_vccnz L_o2_re_152
L_o2_chk_151_go:
  v_mfma_f32_32x32x16_bf16 v[8:23], v[72:75], v[96:99], v[8:23]
  v_mfma_f32_32x32x16_bf16 v[24:39], v[72:75], v[100:103], v[24:39]
  ds_read_b128 v[96:99], v45 offset:28672
  ds_read_b128 v[100:103], v45 offset:30720
  s_waitcnt vmcnt(16) lgkmcnt(2)
L_o2_chk_153:
  v_max3_u32 v4, v76, v77, v78
  v_max_u32 v4, v4, v79
  v_cmp_eq_u32 vcc, -1, v4
  s_nop 1
  s_cbranch_vccnz L_o2_re_154
L_o2_chk_153_go:
  v_mfma_f32_32x32x16_bf16 v[8:23], v[76:79], v[104:107], v[8:23]
  v_mfma_f32_32x32x16_bf16 v[24:39], v[76:79], v[108:111], v[24:39]
  ds_read_b128 v[104:107], v46 offset:28672
  ds_read_b128 v[108:111], v46 offset:30720
  s_waitcnt vmcnt(12) lgkmcnt(2)
L_o2_chk_155:
  v_max3_u32 v4, v80, v81, v82
  v_max_u32 v4, v4, v83
  v_cmp_eq_u32 vcc, -1, v4
  s_nop 1
  s_cbranch_vccnz L_o2_re_156
L_o2_chk_155_go:
  v_mfma_f32_32x32x16_bf16 v[8:23], v[80:83], v[96:99], v[8:23]
  v_mfma_f32_32x32x16_bf16 v[24:39], v[80:83], v[100:103], v[24:39]
  ds_read_b128 v[96:99], v45 offset:32768
  ds_read_b128 v[100:103], v45 offset:34816
  s_waitcnt vmcnt(8) lgkmcnt(2)
L_o2_chk_157:
  v_max3_u32 v4, v84, v85, v86
  v_max_u32 v4, v4, v87
  v_cmp_eq_u32 vcc, -1, v4
  s_nop 1
  s_cbranch_vccnz L_o2_re_158
L_o2_chk_157_go:
  v_mfma_f32_32x32x16_bf16 v[8:23], v[84:87], v[104:107], v[8:23]
  v_mfma_f32_32x32x16_bf16 v[24:39], v[84:87], v[108:111], v[24:39]
  ds_read_b128 v[104:107], v46 offset:32768
  ds_read_b128 v[108:111], v46 offset:34816
  s_waitcnt vmcnt(4) lgkmcnt(2)
L_o2_chk_159:
  v_max3_u32 v4, v88, v89, v90
  v_max_u32 v4, v4, v91
  v_cmp_eq_u32 vcc, -1, v4
  s_nop 1
  s_cbranch_vccnz L_o2_re_160
L_o2_chk_159_go:
  v_mfma_f32_32x32x16_bf16 v[8:23], v[88:91], v[96:99], v[8:23]
  v_mfma_f32_32x32x16_bf16 v[24:39], v[88:91], v[100:103], v[24:39]
  s_waitcnt vmcnt(0) lgkmcnt(0)
L_o2_chk_161:
  v_max3_u32 v4, v92, v93, v94
  v_max_u32 v4, v4, v95
  v_cmp_eq_u32 vcc, -1, v4
  s_nop 1
  s_cbranch_vccnz L_o2_re_162
L_o2_chk_161_go:
  v_mfma_f32_32x32x16_bf16 v[8:23], v[92:95], v[104:107], v[8:23]
  v_mfma_f32_32x32x16_bf16 v[24:39], v[92:95], v[108:111], v[24:39]
  s_nop 15
  s_nop 3
  s_mov_b32 s45, 0
  buffer_store_dword v8, v42, s[32:35], s45 offen offset:0 sc1 nt
  s_mov_b32 s45, 4608
  buffer_store_dword v9, v42, s[32:35], s45 offen offset:0 sc1 nt
  s_mov_b32 s45, 9216
  buffer_store_dword v10, v42, s[32:35], s45 offen offset:0 sc1 nt
  s_mov_b32 s45, 13824
  buffer_store_dword v11, v42, s[32:35], s45 offen offset:0 sc1 nt
  s_mov_b32 s45, 36864
  buffer_store_dword v12, v42, s[32:35], s45 offen offset:0 sc1 nt
  s_mov_b32 s45, 41472
  buffer_store_dword v13, v42, s[32:35], s45 offen offset:0 sc1 nt
  s_mov_b32 s45, 46080
  buffer_store_dword v14, v42, s[32:35], s45 offen offset:0 sc1 nt
  s_mov_b32 s45, 50688
  buffer_store_dword v15, v42, s[32:35], s45 offen offset:0 sc1 nt
  s_mov_b32 s45, 73728
  buffer_store_dword v16, v42, s[32:35], s45 offen offset:0 sc1 nt
  s_mov_b32 s45, 78336
  buffer_store_dword v17, v42, s[32:35], s45 offen offset:0 sc1 nt
  s_mov_b32 s45, 82944
  buffer_store_dword v18, v42, s[32:35], s45 offen offset:0 sc1 nt
  s_mov_b32 s45, 87552
  buffer_store_dword v19, v42, s[32:35], s45 offen offset:0 sc1 nt
  s_mov_b32 s45, 110592
  buffer_store_dword v20, v42, s[32:35], s45 offen offset:0 sc1 nt
  s_mov_b32 s45, 115200
  buffer_store_dword v21, v42, s[32:35], s45 offen offset:0 sc1 nt
  s_mov_b32 s45, 119808
  buffer_store_dword v22, v42, s[32:35], s45 offen offset:0 sc1 nt
  s_mov_b32 s45, 124416
  buffer_store_dword v23, v42, s[32:35], s45 offen offset:0 sc1 nt
  s_mov_b32 s45, 0
  buffer_store_dword v24, v42, s[32:35], s45 offen offset:128 sc1 nt
  s_mov_b32 s45, 4608
  buffer_store_dword v25, v42, s[32:35], s45 offen offset:128 sc1 nt
  s_mov_b32 s45, 9216
  buffer_store_dword v26, v42, s[32:35], s45 offen offset:128 sc1 nt
  s_mov_b32 s45, 13824
  buffer_store_dword v27, v42, s[32:35], s45 offen offset:128 sc1 nt
  s_mov_b32 s45, 36864
  buffer_store_dword v28, v42, s[32:35], s45 offen offset:128 sc1 nt
  s_mov_b32 s45, 41472
  buffer_store_dword v29, v42, s[32:35], s45 offen offset:128 sc1 nt
  s_mov_b32 s45, 46080
  buffer_store_dword v30, v42, s[32:35], s45 offen offset:128 sc1 nt
  s_mov_b32 s45, 50688
  buffer_store_dword v31, v42, s[32:35], s45 offen offset:128 sc1 nt
  s_mov_b32 s45, 73728
  buffer_store_dword v32, v42, s[32:35], s45 offen offset:128 sc1 nt
  s_mov_b32 s45, 78336
  buffer_store_dword v33, v42, s[32:35], s45 offen offset:128 sc1 nt
  s_mov_b32 s45, 82944
  buffer_store_dword v34, v42, s[32:35], s45 offen offset:128 sc1 nt
  s_mov_b32 s45, 87552
  buffer_store_dword v35, v42, s[32:35], s45 offen offset:128 sc1 nt
  s_mov_b32 s45, 110592
  buffer_store_dword v36, v42, s[32:35], s45 offen offset:128 sc1 nt
  s_mov_b32 s45, 115200
  buffer_store_dword v37, v42, s[32:35], s45 offen offset:128 sc1 nt
  s_mov_b32 s45, 119808
  buffer_store_dword v38, v42, s[32:35], s45 offen offset:128 sc1 nt
  s_mov_b32 s45, 124416
  buffer_store_dword v39, v42, s[32:35], s45 offen offset:128 sc1 nt
  s_branch L_o2_exit_87
L_o2_mend_90:
L_o2_re_92:
  s_add_u32 s48, s48, 1
  s_cmp_ge_u32 s48, 60000
  s_cbranch_scc1 L_o2_chk_91_go
  s_sleep 6
  s_add_u32 s49, s47, 0
  buffer_load_dwordx4 v[48:51], v40, s[28:31], s49 offen sc1
  s_waitcnt vmcnt(0)
  s_branch L_o2_chk_91
L_o2_re_94:
  s_add_u32 s48, s48, 1
  s_cmp_ge_u32 s48, 60000
  s_cbranch_scc1 L_o2_chk_93_go
  s_sleep 6
  s_add_u32 s49, s47, 4096
  buffer_load_dwordx4 v[52:55], v40, s[28:31], s49 offen sc1
  s_waitcnt vmcnt(0)
  s_branch L_o2_chk_93
L_o2_re_96:
  s_add_u32 s48, s48, 1
  s_cmp_ge_u32 s48, 60000
  s_cbranch_scc1 L_o2_chk_95_go
  s_sleep 6
  s_add_u32 s49, s47, 8192
  buffer_load_dwordx4 v[56:59], v40, s[28:31], s49 offen sc1
  s_waitcnt vmcnt(0)
  s_branch L_o2_chk_95
L_o2_re_98:
  s_add_u32 s48, s48, 1
  s_cmp_ge_u32 s48, 60000
  s_cbranch_scc1 L_o2_chk_97_go
  s_sleep 6
  s_add_u32 s49, s47, 12288
  buffer_load_dwordx4 v[60:63], v40, s[28:31], s49 offen sc1
  s_waitcnt vmcnt(0)
  s_branch L_o2_chk_97
L_o2_re_100:
  s_add_u32 s48, s48, 1
  s_cmp_ge_u32 s48, 60000
  s_cbranch_scc1 L_o2_chk_99_go
  s_sleep 6
  s_add_u32 s49, s47, 16384
  buffer_load_dwordx4 v[64:67], v40, s[28:31], s49 offen sc1
  s_waitcnt vmcnt(0)
  s_branch L_o2_chk_99
L_o2_re_102:
  s_add_u32 s48, s48, 1
  s_cmp_ge_u32 s48, 60000
  s_cbranch_scc1 L_o2_chk_101_go
  s_sleep 6
  s_add_u32 s49, s47, 20480
  buffer_load_dwordx4 v[68:71], v40, s[28:31], s49 offen sc1
  s_waitcnt vmcnt(0)
  s_branch L_o2_chk_101
L_o2_re_104:
  s_add_u32 s48, s48, 1
  s_cmp_ge_u32 s48, 60000
  s_cbranch_scc1 L_o2_chk_103_go
  s_sleep 6
  s_add_u32 s49, s47, 24576
  buffer_load_dwordx4 v[72:75], v40, s[28:31], s49 offen sc1
  s_waitcnt vmcnt(0)
  s_branch L_o2_chk_103
L_o2_re_106:
  s_add_u32 s48, s48, 1
  s_cmp_ge_u32 s48, 60000
  s_cbranch_scc1 L_o2_chk_105_go
  s_sleep 6
  s_add_u32 s49, s47, 28672
  buffer_load_dwordx4 v[76:79], v40, s[28:31], s49 offen sc1
  s_waitcnt vmcnt(0)
  s_branch L_o2_chk_105
L_o2_re_108:
  s_add_u32 s48, s48, 1
  s_cmp_ge_u32 s48, 60000
  s_cbranch_scc1 L_o2_chk_107_go
  s_sleep 6
  s_add_u32 s49, s47, 32768
  buffer_load_dwordx4 v[80:83], v40, s[28:31], s49 offen sc1
  s_waitcnt vmcnt(0)
  s_branch L_o2_chk_107
L_o2_re_110:
  s_add_u32 s48, s48, 1
  s_cmp_ge_u32 s48, 60000
  s_cbranch_scc1 L_o2_chk_109_go
  s_sleep 6
  s_add_u32 s49, s47, 36864
  buffer_load_dwordx4 v[84:87], v40, s[28:31], s49 offen sc1
  s_waitcnt vmcnt(0)
  s_branch L_o2_chk_109
L_o2_re_112:
  s_add_u32 s48, s48, 1
  s_cmp_ge_u32 s48, 60000
  s_cbranch_scc1 L_o2_chk_111_go
  s_sleep 6
  s_add_u32 s49, s47, 40960
  buffer_load_dwordx4 v[88:91], v40, s[28:31], s49 offen sc1
  s_waitcnt vmcnt(0)
  s_branch L_o2_chk_111
L_o2_re_114:
  s_add_u32 s48, s48, 1
  s_cmp_ge_u32 s48, 60000
  s_cbranch_scc1 L_o2_chk_113_go
  s_sleep 6
  s_add_u32 s49, s47, 45056
  buffer_load_dwordx4 v[92:95], v40, s[28:31], s49 offen sc1
  s_waitcnt vmcnt(0)
  s_branch L_o2_chk_113
L_o2_re_116:
  s_add_u32 s48, s48, 1
  s_cmp_ge_u32 s48, 60000
  s_cbranch_scc1 L_o2_chk_115_go
  s_sleep 6
  s_add_u32 s49, s47, 49152
  buffer_load_dwordx4 v[48:51], v40, s[28:31], s49 offen sc1
  s_waitcnt vmcnt(0)
  s_branch L_o2_chk_115
L_o2_re_118:
  s_add_u32 s48, s48, 1
  s_cmp_ge_u32 s48, 60000
  s_cbranch_scc1 L_o2_chk_117_go
  s_sleep 6
  s_add_u32 s49, s47, 53248
  buffer_load_dwordx4 v[52:55], v40, s[28:31], s49 offen sc1
  s_waitcnt vmcnt(0)
  s_branch L_o2_chk_117
L_o2_re_120:
  s_add_u32 s48, s48, 1
  s_cmp_ge_u32 s48, 60000
  s_cbranch_scc1 L_o2_chk_119_go
  s_sleep 6
  s_add_u32 s49, s47, 57344
  buffer_load_dwordx4 v[56:59], v40, s[28:31], s49 offen sc1
  s_waitcnt vmcnt(0)
  s_branch L_o2_chk_119
L_o2_re_122:
  s_add_u32 s48, s48, 1
  s_cmp_ge_u32 s48, 60000
  s_cbranch_scc1 L_o2_chk_121_go
  s_sleep 6
  s_add_u32 s49, s47, 61440
  buffer_load_dwordx4 v[60:63], v40, s[28:31], s49 offen sc1
  s_waitcnt vmcnt(0)
  s_branch L_o2_chk_121
L_o2_re_124:
  s_add_u32 s48, s48, 1
  s_cmp_ge_u32 s48, 60000
  s_cbranch_scc1 L_o2_chk_123_go
  s_sleep 6
  s_add_u32 s49, s47, 65536
  buffer_load_dwordx4 v[64:67], v40, s[28:31], s49 offen sc1
  s_waitcnt vmcnt(0)
  s_branch L_o2_chk_123
L_o2_re_126:
  s_add_u32 s48, s48, 1
  s_cmp_ge_u32 s48, 60000
  s_cbranch_scc1 L_o2_chk_125_go
  s_sleep 6
  s_add_u32 s49, s47, 69632
  buffer_load_dwordx4 v[68:71], v40, s[28:31], s49 offen sc1
  s_waitcnt vmcnt(0)
  s_branch L_o2_chk_125
L_o2_re_128:
  s_add_u32 s48, s48, 1
  s_cmp_ge_u32 s48, 60000
  s_cbranch_scc1 L_o2_chk_127_go
  s_sleep 6
  s_add_u32 s49, s47, 73728
  buffer_load_dwordx4 v[72:75], v40, s[28:31], s49 offen sc1
  s_waitcnt vmcnt(0)
  s_branch L_o2_chk_127
L_o2_re_130:
  s_add_u32 s48, s48, 1
  s_cmp_ge_u32 s48, 60000
  s_cbranch_scc1 L_o2_chk_129_go
  s_sleep 6
  s_add_u32 s49, s47, 77824
  buffer_load_dwordx4 v[76:79], v40, s[28:31], s49 offen sc1
  s_waitcnt vmcnt(0)
  s_branch L_o2_chk_129
L_o2_re_132:
  s_add_u32 s48, s48, 1
  s_cmp_ge_u32 s48, 60000
  s_cbranch_scc1 L_o2_chk_131_go
  s_sleep 6
  s_add_u32 s49, s47, 81920
  buffer_load_dwordx4 v[80:83], v40, s[28:31], s49 offen sc1
  s_waitcnt vmcnt(0)
  s_branch L_o2_chk_131
L_o2_re_134:
  s_add_u32 s48, s48, 1
  s_cmp_ge_u32 s48, 60000
  s_cbranch_scc1 L_o2_chk_133_go
  s_sleep 6
  s_add_u32 s49, s47, 86016
  buffer_load_dwordx4 v[84:87], v40, s[28:31], s49 offen sc1
  s_waitcnt vmcnt(0)
  s_branch L_o2_chk_133
L_o2_re_136:
  s_add_u32 s48, s48, 1
  s_cmp_ge_u32 s48, 60000
  s_cbranch_scc1 L_o2_chk_135_go
  s_sleep 6
  s_add_u32 s49, s47, 90112
  buffer_load_dwordx4 v[88:91], v40, s[28:31], s49 offen sc1
  s_waitcnt vmcnt(0)
  s_branch L_o2_chk_135
L_o2_re_138:
  s_add_u32 s48, s48, 1
  s_cmp_ge_u32 s48, 60000
  s_cbranch_scc1 L_o2_chk_137_go
  s_sleep 6
  s_add_u32 s49, s47, 94208
  buffer_load_dwordx4 v[92:95], v40, s[28:31], s49 offen sc1
  s_waitcnt vmcnt(0)
  s_branch L_o2_chk_137
L_o2_re_140:
  s_add_u32 s48, s48, 1
  s_cmp_ge_u32 s48, 60000
  s_cbranch_scc1 L_o2_chk_139_go
  s_sleep 6
  s_add_u32 s49, s47, 98304
  buffer_load_dwordx4 v[48:51], v40, s[28:31], s49 offen sc1
  s_waitcnt vmcnt(0)
  s_branch L_o2_chk_139
L_o2_re_142:
  s_add_u32 s48, s48, 1
  s_cmp_ge_u32 s48, 60000
  s_cbranch_scc1 L_o2_chk_141_go
  s_sleep 6
  s_add_u32 s49, s47, 102400
  buffer_load_dwordx4 v[52:55], v40, s[28:31], s49 offen sc1
  s_waitcnt vmcnt(0)
  s_branch L_o2_chk_141
L_o2_re_144:
  s_add_u32 s48, s48, 1
  s_cmp_ge_u32 s48, 60000
  s_cbranch_scc1 L_o2_chk_143_go
  s_sleep 6
  s_add_u32 s49, s47, 106496
  buffer_load_dwordx4 v[56:59], v40, s[28:31], s49 offen sc1
  s_waitcnt vmcnt(0)
  s_branch L_o2_chk_143
L_o2_re_146:
  s_add_u32 s48, s48, 1
  s_cmp_ge_u32 s48, 60000
  s_cbranch_scc1 L_o2_chk_145_go
  s_sleep 6
  s_add_u32 s49, s47, 110592
  buffer_load_dwordx4 v[60:63], v40, s[28:31], s49 offen sc1
  s_waitcnt vmcnt(0)
  s_branch L_o2_chk_145
L_o2_re_148:
  s_add_u32 s48, s48, 1
  s_cmp_ge_u32 s48, 60000
  s_cbranch_scc1 L_o2_chk_147_go
  s_sleep 6
  s_add_u32 s49, s47, 114688
  buffer_load_dwordx4 v[64:67], v40, s[28:31], s49 offen sc1
  s_waitcnt vmcnt(0)
  s_branch L_o2_chk_147
L_o2_re_150:
  s_add_u32 s48, s48, 1
  s_cmp_ge_u32 s48, 60000
  s_cbranch_scc1 L_o2_chk_149_go
  s_sleep 6
  s_add_u32 s49, s47, 118784
  buffer_load_dwordx4 v[68:71], v40, s[28:31], s49 offen sc1
  s_waitcnt vmcnt(0)
  s_branch L_o2_chk_149
L_o2_re_152:
  s_add_u32 s48, s48, 1
  s_cmp_ge_u32 s48, 60000
  s_cbranch_scc1 L_o2_chk_151_go
  s_sleep 6
  s_add_u32 s49, s47, 122880
  buffer_load_dwordx4 v[72:75], v40, s[28:31], s49 offen sc1
  s_waitcnt vmcnt(0)
  s_branch L_o2_chk_151
L_o2_re_154:
  s_add_u32 s48, s48, 1
  s_cmp_ge_u32 s48, 60000
  s_cbranch_scc1 L_o2_chk_153_go
  s_sleep 6
  s_add_u32 s49, s47, 126976
  buffer_load_dwordx4 v[76:79], v40, s[28:31], s49 offen sc1
  s_waitcnt vmcnt(0)
  s_branch L_o2_chk_153
L_o2_re_156:
  s_add_u32 s48, s48, 1
  s_cmp_ge_u32 s48, 60000
  s_cbranch_scc1 L_o2_chk_155_go
  s_sleep 6
  s_add_u32 s49, s46, 0
  buffer_load_dword v80, v41, s[28:31], s49 offen offset:0 sc1
  buffer_load_dword v81, v41, s[28:31], s49 offen offset:512 sc1
  buffer_load_dword v82, v41, s[28:31], s49 offen offset:1024 sc1
  buffer_load_dword v83, v41, s[28:31], s49 offen offset:1536 sc1
  s_waitcnt vmcnt(0)
  s_branch L_o2_chk_155
L_o2_re_158:
  s_add_u32 s48, s48, 1
  s_cmp_ge_u32 s48, 60000
  s_cbranch_scc1 L_o2_chk_157_go
  s_sleep 6
  s_add_u32 s49, s46, 4096
  buffer_load_dword v84, v41, s[28:31], s49 offen offset:0 sc1
  buffer_load_dword v85, v41, s[28:31], s49 offen offset:512 sc1
  buffer_load_dword v86, v41, s[28:31], s49 offen offset:1024 sc1
  buffer_load_dword v87, v41, s[28:31], s49 offen offset:1536 sc1
  s_waitcnt vmcnt(0)
  s_branch L_o2_chk_157
L_o2_re_160:
  s_add_u32 s48, s48, 1
  s_cmp_ge_u32 s48, 60000
  s_cbranch_scc1 L_o2_chk_159_go
  s_sleep 6
  s_add_u32 s49, s46, 8192
  buffer_load_dword v88, v41, s[28:31], s49 offen offset:0 sc1
  buffer_load_dword v89, v41, s[28:31], s49 offen offset:512 sc1
  buffer_load_dword v90, v41, s[28:31], s49 offen offset:1024 sc1
  buffer_load_dword v91, v41, s[28:31], s49 offen offset:1536 sc1
  s_waitcnt vmcnt(0)
  s_branch L_o2_chk_159
L_o2_re_162:
  s_add_u32 s48, s48, 1
  s_cmp_ge_u32 s48, 60000
  s_cbranch_scc1 L_o2_chk_161_go
  s_sleep 6
  s_add_u32 s49, s46, 12288
  buffer_load_dword v92, v41, s[28:31], s49 offen offset:0 sc1
  buffer_load_dword v93, v41, s[28:31], s49 offen offset:512 sc1
  buffer_load_dword v94, v41, s[28:31], s49 offen offset:1024 sc1
  buffer_load_dword v95, v41, s[28:31], s49 offen offset:1536 sc1
  s_waitcnt vmcnt(0)
  s_branch L_o2_chk_161
L_o2_loader_86:
  s_sub_u32 s21, s20, 4
  v_lshlrev_b32 v8, 4, v1
  s_lshl_b32 s22, s21, 10
  s_mul_i32 s45, s27, 73728
  s_add_u32 s45, s45, s22
  s_add_u32 s45, s45, 9703424
  s_mov_b32 s24, 0
L_o2_l_163:
  s_mov_b32 m0, s22
  s_add_u32 s22, s22, 4096
  buffer_load_dwordx4 v8, s[28:31], s45 offen lds
  s_add_u32 s45, s45, 4096
  s_add_u32 s24, s24, 1
  s_cmp_lt_u32 s24, 18
  s_cbranch_scc1 L_o2_l_163
  s_getpc_b64 s[50:51]
L_o2_pc_164:
  s_sub_u32 s50, s50, (L_o2_pc_164 - L_o2_main_89)
  s_subb_u32 s51, s51, 0
  s_lshl_b32 s52, s21, 6
  v_add_u32 v2, s52, v1
  v_lshlrev_b32 v2, 6, v2
  s_mov_b32 s52, (L_o2_mend_90 - L_o2_main_89)
  v_cmp_gt_u32 vcc, s52, v2
  v_mov_b32 v13, s51
  v_add_co_u32 v12, s[56:57], s50, v2
  s_nop 1
  v_addc_co_u32 v13, s[56:57], 0, v13, s[56:57]
  s_and_saveexec_b64 s[54:55], vcc
  s_cbranch_execz L_o2_pc_164_x
  global_load_dword v3, v[12:13], off
L_o2_pc_164_x:
  s_mov_b64 exec, -1
  s_waitcnt vmcnt(0)
  s_barrier
L_o2_exit_87:
  s_branch L_k2_fin
L_k2_fin:
  s_endpgm
L_k2_exit:
  s_endpgm
L_code_end:
  s_endpgm
.section .rodata,"a"
.p2align 6
.amdhsa_kernel k1_kernel
  .amdhsa_next_free_vgpr 232
  .amdhsa_next_free_sgpr 102
  .amdhsa_accum_offset 232
  .amdhsa_group_segment_fixed_size 0
  .amdhsa_kernarg_size 120
  .amdhsa_user_sgpr_count 2
  .amdhsa_user_sgpr_kernarg_segment_ptr 1
  .amdhsa_system_sgpr_workgroup_id_x 1
  .amdhsa_float_denorm_mode_32 3
  .amdhsa_float_denorm_mode_16_64 3
  .amdhsa_ieee_mode 0
  .amdhsa_dx10_clamp 1
.end_amdhsa_kernel

.p2align 6
.amdhsa_kernel k2_kernel
  .amdhsa_next_free_vgpr 128
  .amdhsa_next_free_sgpr 102
  .amdhsa_accum_offset 128
  .amdhsa_group_segment_fixed_size 0
  .amdhsa_kernarg_size 120
  .amdhsa_user_sgpr_count 2
  .amdhsa_user_sgpr_kernarg_segment_ptr 1
  .amdhsa_system_sgpr_workgroup_id_x 1
  .amdhsa_float_denorm_mode_32 3
  .amdhsa_float_denorm_mode_16_64 3
  .amdhsa_ieee_mode 0
  .amdhsa_dx10_clamp 1
.end_amdhsa_kernel
```
